```python
import torch

def _softmax(x, axis=-1):
    return torch.softmax(x, dim=axis)
def _gelu(x):
    return torch.nn.functional.gelu(x, approximate="tanh")
def _silu(x):
    return torch.nn.functional.silu(x)
def _sigmoid(x):
    return torch.sigmoid(x)
def _layernorm(x, axis=-1, eps=1e-5):
    m = x.mean(dim=axis, keepdim=True)
    v = x.var(dim=axis, keepdim=True, unbiased=False)
    return (x - m) / torch.sqrt(v + eps)
def _scatter_add(tgt, idx, src, axis=0):
    return tgt.clone().index_add_(axis, idx, src)
def _segment_sum(src, seg, n):
    out = torch.zeros((n,) + src.shape[1:], dtype=src.dtype)
    return out.index_add_(0, seg, src)
def _pad(x, pw):
    flat = tuple(v for pair in reversed(pw) for v in pair)
    return torch.nn.functional.pad(x, flat)

kernel_name = 'parallel_sum__mha_block__dense_activation_gelu__prompt'

def setup_inputs():

    _w = (lambda a: (lambda t: t.to(torch.bfloat16) if t.is_floating_point() else t)(torch.as_tensor(a)))
    def _A_setup():
        B, S, D, H = 1, 2048, 512, 32
        return {
            "x": _w((lambda *s: torch.randn(*s, dtype=torch.bfloat16) * 0.05)(B, S, D)),
            "wqkv": _w((lambda *s: torch.randn(*s, dtype=torch.bfloat16) * 0.05)(D, 3 * D)),
            "wo": _w((lambda *s: torch.randn(*s, dtype=torch.bfloat16) * 0.05)(D, D)),
        }
    _A_in = _A_setup()

    def _B_setup():
        B, S, D, F = 1, 2048, 512, 1792
        return {
            "x": _w((lambda *s: torch.randn(*s, dtype=torch.bfloat16) * 0.05)(B, S, D)),
            "w1": _w((lambda *s: torch.randn(*s, dtype=torch.bfloat16) * 0.8)(D, F) * (D ** -0.5)),
            "b1": _w((lambda *s: torch.randn(*s, dtype=torch.bfloat16) * 12.8)(F) * 0.01),
            "w2": _w((lambda *s: torch.randn(*s, dtype=torch.bfloat16) * 0.8)(F, D) * (F ** -0.5)),
            "b2": _w((lambda *s: torch.randn(*s, dtype=torch.bfloat16) * 12.8)(D) * 0.01),
        }
    _B_in = _B_setup()

    return {
        "A_x": _A_in["x"],
        "A_wqkv": _A_in["wqkv"],
        "A_wo": _A_in["wo"],
        "B_x": _B_in["x"],
        "B_w1": _B_in["w1"],
        "B_b1": _B_in["b1"],
        "B_w2": _B_in["w2"],
        "B_b2": _B_in["b2"],
    }

def reference(A_x, A_wqkv, A_wo, B_x, B_w1, B_b1, B_w2, B_b2):
    def _A_ref(x, wqkv, wo):
        B, S, D = x.shape
        H = 32
        Dh = D // H
        qkv = (lambda x, *d: x.permute(*d))((x @ wqkv).reshape(B, S, 3, H, Dh), 2, 0, 3, 1, 4)
        q, k, v = qkv[0], qkv[1], qkv[2]
        scores = torch.einsum("bhqd,bhkd->bhqk", q, k) * (Dh ** -0.5)
        p = _softmax(scores, axis=-1)
        o = torch.einsum("bhqk,bhkd->bhqd", p, v)
        return (lambda x, *d: x.permute(*d))(o, 0, 2, 1, 3).reshape(B, S, D) @ wo

    def _B_ref(x, w1, b1, w2, b2):
        h = torch.einsum("bsd,df->bsf", x, w1) + b1
        h = _gelu(h)
        return torch.einsum("bsf,fd->bsd", h, w2) + b2

    x = A_x
    xn = _layernorm(x, axis=-1)
    return x + _A_ref(xn, A_wqkv, A_wo) + _B_ref(xn, B_w1, B_b1, B_w2, B_b2)
```

```asm
; @launch kernel=k1_kernel grid=(244,1,1) block=(512,1,1) lds=147456
; @launch kernel=k2_kernel grid=(256,1,1) block=(768,1,1) lds=135168
; @launch kernel=k3_kernel grid=(256,1,1) block=(512,1,1) lds=16384
.amdgcn_target "amdgcn-amd-amdhsa--gfx950"
.text
.globl k1_kernel
.p2align 8
.type k1_kernel,@function
k1_kernel:
    s_cmp_ge_u32 s2, 244
    s_cbranch_scc1 k1_kernel_exit
    s_load_dwordx2 s[60:61], s[0:1], 0
    s_load_dwordx2 s[62:63], s[0:1], 8
    s_load_dwordx2 s[64:65], s[0:1], 32
    s_load_dwordx2 s[66:67], s[0:1], 80
    s_load_dwordx2 s[68:69], s[0:1], 40
    s_load_dwordx2 s[70:71], s[0:1], 16
    s_load_dwordx2 s[72:73], s[0:1], 48
    v_and_b32 v1, 63, v0
    v_lshrrev_b32 v2, 6, v0
    s_nop 0
    v_readfirstlane_b32 s20, v2
    s_waitcnt lgkmcnt(0)
    s_mov_b32 s4, s60
    s_and_b32 s5, s61, 0xffff
    s_mov_b32 s6, 0x200000
    s_mov_b32 s7, 0x00020000
    s_mov_b32 s12, s66
    s_and_b32 s13, s67, 0xffff
    s_mov_b32 s14, 0x10000000
    s_mov_b32 s15, 0x00020000
    s_mov_b32 s16, s68
    s_and_b32 s17, s69, 0xffff
    s_mov_b32 s18, 0xe00
    s_mov_b32 s19, 0x00020000
    s_cmp_ge_u32 s2, 208
    s_cbranch_scc1 k1_kernel_transposer
    s_and_b32 s40, s2, 7
    s_lshr_b32 s41, s2, 3
    s_lshr_b32 s42, s40, 1
    s_lshl_b32 s42, s42, 1
    s_and_b32 s43, s41, 1
    s_add_u32 s23, s42, s43
    s_and_b32 s44, s40, 1
    s_mul_i32 s44, s44, 13
    s_lshr_b32 s45, s41, 1
    s_add_u32 s24, s44, s45
    s_lshr_b32 s21, s20, 1
    s_and_b32 s22, s20, 1
    s_cmp_ge_u32 s24, 12
    s_mov_b32 s8, s62
    s_cmov_b32 s8, s64
    s_mov_b32 s9, s63
    s_cmov_b32 s9, s65
    s_mov_b32 s10, 0x180000
    s_cmov_b32 s10, 0x1C0000
    s_mov_b32 s25, 3072
    s_cmov_b32 s25, 3584
    s_mov_b32 s46, 0
    s_cmov_b32 s46, 12
    s_and_b32 s9, s9, 0xffff
    s_mov_b32 s11, 0x00020000
    s_sub_u32 s46, s24, s46
    s_lshl_b32 s26, s46, 8
    v_and_b32 v2, 31, v1
    v_lshrrev_b32 v3, 5, v1
    v_bfe_u32 v4, v2, 1, 3
    s_lshl_b32 s46, s21, 1
    s_add_u32 s34, s46, s22
    s_lshl_b32 s46, s22, 1
    s_and_b32 s47, s21, 1
    s_add_u32 s36, s46, s47
    s_lshl_b32 s47, s34, 12
    v_lshlrev_b32 v5, 7, v2
    v_add_u32 v5, s47, v5
    v_or_b32 v6, 0, v3
    v_xor_b32 v6, v6, v4
    v_lshl_add_u32 v16, v6, 4, v5
    v_xor_b32 v20, 0x1000, v16
    v_or_b32 v6, 2, v3
    v_xor_b32 v6, v6, v4
    v_lshl_add_u32 v17, v6, 4, v5
    v_xor_b32 v21, 0x1000, v17
    v_or_b32 v6, 4, v3
    v_xor_b32 v6, v6, v4
    v_lshl_add_u32 v18, v6, 4, v5
    v_xor_b32 v22, 0x1000, v18
    v_or_b32 v6, 6, v3
    v_xor_b32 v6, v6, v4
    v_lshl_add_u32 v19, v6, 4, v5
    v_xor_b32 v23, 0x1000, v19
    v_lshrrev_b32 v6, 4, v1
    v_bfe_u32 v7, v1, 2, 2
    v_and_b32 v8, 3, v1
    v_lshrrev_b32 v9, 1, v6
    v_lshl_add_u32 v9, v9, 3, v7
    v_lshlrev_b32 v9, 8, v9
    v_and_b32 v10, 1, v6
    v_lshl_add_u32 v9, v10, 5, v9
    v_lshl_add_u32 v9, v8, 3, v9
    v_add_u32 v9, 0x8000, v9
    v_xor_b32 v10, s36, v7
    v_lshl_add_u32 v24, v10, 6, v9
    v_xor_b32 v10, 1, v10
    v_lshl_add_u32 v25, v10, 6, v9
    v_lshrrev_b32 v6, 4, v1
    v_and_b32 v7, 7, v1
    v_xor_b32 v8, v7, v6
    v_lshrrev_b32 v9, 3, v1
    v_lshlrev_b32 v9, 10, v9
    v_lshl_add_u32 v26, v8, 4, v9
    v_or_b32 v8, 4, v6
    v_xor_b32 v8, v7, v8
    v_lshl_add_u32 v27, v8, 4, v9
    v_and_b32 v7, 15, v1
    v_lshlrev_b32 v8, 2, v6
    v_xor_b32 v8, v7, v8
    v_lshlrev_b32 v8, 4, v8
    v_mul_lo_u32 v9, v6, s25
    v_add_u32 v28, v8, v9
    v_mov_b32 v29, 0xffff0000
    s_lshl_b32 s27, s23, 8
    s_lshl_b32 s46, s20, 5
    s_add_u32 s27, s27, s46
    s_lshl_b32 s27, s27, 10
    s_lshl_b32 s46, s20, 3
    s_mul_i32 s28, s46, s25
    s_add_u32 s28, s28, s26
    s_lshl_b32 s29, s20, 12
    s_lshl_b32 s38, s20, 11
    s_add_u32 s38, s38, 0x8000
    s_lshl_b32 s30, s25, 2
    s_lshl_b32 s33, s25, 6
    s_mov_b32 s39, 0
    s_mov_b32 s42, 0
    v_mov_b32 v64, 0
    v_mov_b32 v65, 0
    v_mov_b32 v66, 0
    v_mov_b32 v67, 0
    v_mov_b32 v68, 0
    v_mov_b32 v69, 0
    v_mov_b32 v70, 0
    v_mov_b32 v71, 0
    v_mov_b32 v72, 0
    v_mov_b32 v73, 0
    v_mov_b32 v74, 0
    v_mov_b32 v75, 0
    v_mov_b32 v76, 0
    v_mov_b32 v77, 0
    v_mov_b32 v78, 0
    v_mov_b32 v79, 0
    v_mov_b32 v80, 0
    v_mov_b32 v81, 0
    v_mov_b32 v82, 0
    v_mov_b32 v83, 0
    v_mov_b32 v84, 0
    v_mov_b32 v85, 0
    v_mov_b32 v86, 0
    v_mov_b32 v87, 0
    v_mov_b32 v88, 0
    v_mov_b32 v89, 0
    v_mov_b32 v90, 0
    v_mov_b32 v91, 0
    v_mov_b32 v92, 0
    v_mov_b32 v93, 0
    v_mov_b32 v94, 0
    v_mov_b32 v95, 0
    v_mov_b32 v96, 0
    v_mov_b32 v97, 0
    v_mov_b32 v98, 0
    v_mov_b32 v99, 0
    v_mov_b32 v100, 0
    v_mov_b32 v101, 0
    v_mov_b32 v102, 0
    v_mov_b32 v103, 0
    v_mov_b32 v104, 0
    v_mov_b32 v105, 0
    v_mov_b32 v106, 0
    v_mov_b32 v107, 0
    v_mov_b32 v108, 0
    v_mov_b32 v109, 0
    v_mov_b32 v110, 0
    v_mov_b32 v111, 0
    v_mov_b32 v112, 0
    v_mov_b32 v113, 0
    v_mov_b32 v114, 0
    v_mov_b32 v115, 0
    v_mov_b32 v116, 0
    v_mov_b32 v117, 0
    v_mov_b32 v118, 0
    v_mov_b32 v119, 0
    v_mov_b32 v120, 0
    v_mov_b32 v121, 0
    v_mov_b32 v122, 0
    v_mov_b32 v123, 0
    v_mov_b32 v124, 0
    v_mov_b32 v125, 0
    v_mov_b32 v126, 0
    v_mov_b32 v127, 0
    v_mov_b32 v128, 0
    v_mov_b32 v129, 0
    v_mov_b32 v130, 0
    v_mov_b32 v131, 0
    v_mov_b32 v132, 0
    v_mov_b32 v133, 0
    v_mov_b32 v134, 0
    v_mov_b32 v135, 0
    v_mov_b32 v136, 0
    v_mov_b32 v137, 0
    v_mov_b32 v138, 0
    v_mov_b32 v139, 0
    v_mov_b32 v140, 0
    v_mov_b32 v141, 0
    v_mov_b32 v142, 0
    v_mov_b32 v143, 0
    v_mov_b32 v144, 0
    v_mov_b32 v145, 0
    v_mov_b32 v146, 0
    v_mov_b32 v147, 0
    v_mov_b32 v148, 0
    v_mov_b32 v149, 0
    v_mov_b32 v150, 0
    v_mov_b32 v151, 0
    v_mov_b32 v152, 0
    v_mov_b32 v153, 0
    v_mov_b32 v154, 0
    v_mov_b32 v155, 0
    v_mov_b32 v156, 0
    v_mov_b32 v157, 0
    v_mov_b32 v158, 0
    v_mov_b32 v159, 0
    v_mov_b32 v160, 0x3f803f80
    v_mov_b32 v161, 0x3f803f80
    v_mov_b32 v162, 0x3f803f80
    v_mov_b32 v163, 0x3f803f80
    s_cmp_ge_u32 s24, 8
    s_cselect_b32 s46, 1, 0
    s_cmp_lt_u32 s24, 12
    s_cselect_b32 s47, 1, 0
    s_and_b32 s46, s46, s47
    s_cmp_eq_u32 s46, 1
    s_cbranch_scc1 k1_kernel_vrole
    s_add_u32 s46, s29, s39
    s_add_u32 m0, s46, 0
    s_add_u32 s46, s27, 0
    buffer_load_dwordx4 v26, s[4:7], s46 offen lds
    s_add_u32 s46, s29, s39
    s_add_u32 m0, s46, 1024
    s_add_u32 s46, s27, 8192
    buffer_load_dwordx4 v27, s[4:7], s46 offen lds
    s_add_u32 s46, s29, s39
    s_add_u32 m0, s46, 2048
    s_add_u32 s46, s27, 16384
    buffer_load_dwordx4 v26, s[4:7], s46 offen lds
    s_add_u32 s46, s29, s39
    s_add_u32 m0, s46, 3072
    s_add_u32 s46, s27, 24576
    buffer_load_dwordx4 v27, s[4:7], s46 offen lds
    s_add_u32 m0, s38, s39
    s_nop 0
    buffer_load_dwordx4 v28, s[8:11], s28 offen lds
    s_add_u32 s46, s38, s39
    s_add_u32 m0, s46, 1024
    s_add_u32 s46, s28, s30
    buffer_load_dwordx4 v28, s[8:11], s46 offen lds
    s_add_u32 s27, s27, 128
    s_add_u32 s28, s28, s33
    s_add_u32 s39, s39, 49152
    s_cmp_eq_u32 s39, 147456
    s_cmov_b32 s39, 0
    s_add_u32 s46, s29, s39
    s_add_u32 m0, s46, 0
    s_add_u32 s46, s27, 0
    buffer_load_dwordx4 v26, s[4:7], s46 offen lds
    s_add_u32 s46, s29, s39
    s_add_u32 m0, s46, 1024
    s_add_u32 s46, s27, 8192
    buffer_load_dwordx4 v27, s[4:7], s46 offen lds
    s_add_u32 s46, s29, s39
    s_add_u32 m0, s46, 2048
    s_add_u32 s46, s27, 16384
    buffer_load_dwordx4 v26, s[4:7], s46 offen lds
    s_add_u32 s46, s29, s39
    s_add_u32 m0, s46, 3072
    s_add_u32 s46, s27, 24576
    buffer_load_dwordx4 v27, s[4:7], s46 offen lds
    s_add_u32 m0, s38, s39
    s_nop 0
    buffer_load_dwordx4 v28, s[8:11], s28 offen lds
    s_add_u32 s46, s38, s39
    s_add_u32 m0, s46, 1024
    s_add_u32 s46, s28, s30
    buffer_load_dwordx4 v28, s[8:11], s46 offen lds
    s_add_u32 s27, s27, 128
    s_add_u32 s28, s28, s33
    s_add_u32 s39, s39, 49152
    s_cmp_eq_u32 s39, 147456
    s_cmov_b32 s39, 0
    s_mov_b32 s40, 0
k1_kernel_ml_CT:
    s_cmp_lt_u32 s40, 7
    s_cbranch_scc1 k1_kernel_ml_CT_w
    s_waitcnt vmcnt(0)
k1_kernel_ml_CT_w:
    s_waitcnt vmcnt(6)
    s_barrier
    s_cmp_ge_u32 s40, 6
    s_cbranch_scc1 k1_kernel_ml_CT_nd
    s_add_u32 s46, s29, s39
    s_add_u32 m0, s46, 0
    s_add_u32 s46, s27, 0
    buffer_load_dwordx4 v26, s[4:7], s46 offen lds
    s_add_u32 s46, s29, s39
    s_add_u32 m0, s46, 1024
    s_add_u32 s46, s27, 8192
    buffer_load_dwordx4 v27, s[4:7], s46 offen lds
    s_add_u32 s46, s29, s39
    s_add_u32 m0, s46, 2048
    s_add_u32 s46, s27, 16384
    buffer_load_dwordx4 v26, s[4:7], s46 offen lds
    s_add_u32 s46, s29, s39
    s_add_u32 m0, s46, 3072
    s_add_u32 s46, s27, 24576
    buffer_load_dwordx4 v27, s[4:7], s46 offen lds
    s_add_u32 m0, s38, s39
    s_nop 0
    buffer_load_dwordx4 v28, s[8:11], s28 offen lds
    s_add_u32 s46, s38, s39
    s_add_u32 m0, s46, 1024
    s_add_u32 s46, s28, s30
    buffer_load_dwordx4 v28, s[8:11], s46 offen lds
    s_add_u32 s27, s27, 128
    s_add_u32 s28, s28, s33
    s_add_u32 s39, s39, 49152
    s_cmp_eq_u32 s39, 147456
    s_cmov_b32 s39, 0
k1_kernel_ml_CT_nd:
    ds_read_b128 v[32:35], v16
    ds_read_b128 v[36:39], v20
    ds_read_b64_tr_b16 v[40:41], v24 offset:0
    ds_read_b64_tr_b16 v[42:43], v24 offset:1024
    ds_read_b64_tr_b16 v[44:45], v25 offset:0
    ds_read_b64_tr_b16 v[46:47], v25 offset:1024
    ds_read_b128 v[48:51], v17
    ds_read_b128 v[52:55], v21
    ds_read_b64_tr_b16 v[56:57], v24 offset:4096
    ds_read_b64_tr_b16 v[58:59], v24 offset:5120
    ds_read_b64_tr_b16 v[60:61], v25 offset:4096
    ds_read_b64_tr_b16 v[62:63], v25 offset:5120
    s_waitcnt lgkmcnt(6)
    v_mfma_f32_32x32x16_bf16 v[64:79], v[40:43], v[32:35], v[64:79]
    v_and_b32 v140, v29, v32
    v_lshlrev_b32 v141, 16, v32
    v_add_f32 v128, v128, v140
    v_add_f32 v129, v129, v141
    v_fmac_f32 v130, v140, v140
    v_fmac_f32 v131, v141, v141
    v_mfma_f32_32x32x16_bf16 v[80:95], v[44:47], v[32:35], v[80:95]
    v_and_b32 v140, v29, v33
    v_lshlrev_b32 v141, 16, v33
    v_add_f32 v132, v132, v140
    v_add_f32 v133, v133, v141
    v_fmac_f32 v134, v140, v140
    v_fmac_f32 v135, v141, v141
    v_mfma_f32_32x32x16_bf16 v[96:111], v[40:43], v[36:39], v[96:111]
    v_and_b32 v140, v29, v34
    v_lshlrev_b32 v141, 16, v34
    v_add_f32 v128, v128, v140
    v_add_f32 v129, v129, v141
    v_fmac_f32 v130, v140, v140
    v_fmac_f32 v131, v141, v141
    v_mfma_f32_32x32x16_bf16 v[112:127], v[44:47], v[36:39], v[112:127]
    v_and_b32 v140, v29, v35
    v_lshlrev_b32 v141, 16, v35
    v_add_f32 v132, v132, v140
    v_add_f32 v133, v133, v141
    v_fmac_f32 v134, v140, v140
    v_fmac_f32 v135, v141, v141
    v_mfma_f32_32x32x16_bf16 v[144:159], v[40:43], v[160:163], v[144:159]
    ds_read_b128 v[32:35], v18
    ds_read_b128 v[36:39], v22
    ds_read_b64_tr_b16 v[40:41], v24 offset:8192
    ds_read_b64_tr_b16 v[42:43], v24 offset:9216
    ds_read_b64_tr_b16 v[44:45], v25 offset:8192
    ds_read_b64_tr_b16 v[46:47], v25 offset:9216
    s_waitcnt lgkmcnt(6)
    v_mfma_f32_32x32x16_bf16 v[64:79], v[56:59], v[48:51], v[64:79]
    v_and_b32 v140, v29, v48
    v_lshlrev_b32 v141, 16, v48
    v_add_f32 v128, v128, v140
    v_add_f32 v129, v129, v141
    v_fmac_f32 v130, v140, v140
    v_fmac_f32 v131, v141, v141
    v_mfma_f32_32x32x16_bf16 v[80:95], v[60:63], v[48:51], v[80:95]
    v_and_b32 v140, v29, v49
    v_lshlrev_b32 v141, 16, v49
    v_add_f32 v132, v132, v140
    v_add_f32 v133, v133, v141
    v_fmac_f32 v134, v140, v140
    v_fmac_f32 v135, v141, v141
    v_mfma_f32_32x32x16_bf16 v[96:111], v[56:59], v[52:55], v[96:111]
    v_and_b32 v140, v29, v50
    v_lshlrev_b32 v141, 16, v50
    v_add_f32 v128, v128, v140
    v_add_f32 v129, v129, v141
    v_fmac_f32 v130, v140, v140
    v_fmac_f32 v131, v141, v141
    v_mfma_f32_32x32x16_bf16 v[112:127], v[60:63], v[52:55], v[112:127]
    v_and_b32 v140, v29, v51
    v_lshlrev_b32 v141, 16, v51
    v_add_f32 v132, v132, v140
    v_add_f32 v133, v133, v141
    v_fmac_f32 v134, v140, v140
    v_fmac_f32 v135, v141, v141
    v_mfma_f32_32x32x16_bf16 v[144:159], v[56:59], v[160:163], v[144:159]
    ds_read_b128 v[48:51], v19
    ds_read_b128 v[52:55], v23
    ds_read_b64_tr_b16 v[56:57], v24 offset:12288
    ds_read_b64_tr_b16 v[58:59], v24 offset:13312
    ds_read_b64_tr_b16 v[60:61], v25 offset:12288
    ds_read_b64_tr_b16 v[62:63], v25 offset:13312
    s_waitcnt lgkmcnt(6)
    v_mfma_f32_32x32x16_bf16 v[64:79], v[40:43], v[32:35], v[64:79]
    v_and_b32 v140, v29, v32
    v_lshlrev_b32 v141, 16, v32
    v_add_f32 v128, v128, v140
    v_add_f32 v129, v129, v141
    v_fmac_f32 v130, v140, v140
    v_fmac_f32 v131, v141, v141
    v_mfma_f32_32x32x16_bf16 v[80:95], v[44:47], v[32:35], v[80:95]
    v_and_b32 v140, v29, v33
    v_lshlrev_b32 v141, 16, v33
    v_add_f32 v132, v132, v140
    v_add_f32 v133, v133, v141
    v_fmac_f32 v134, v140, v140
    v_fmac_f32 v135, v141, v141
    v_mfma_f32_32x32x16_bf16 v[96:111], v[40:43], v[36:39], v[96:111]
    v_and_b32 v140, v29, v34
    v_lshlrev_b32 v141, 16, v34
    v_add_f32 v128, v128, v140
    v_add_f32 v129, v129, v141
    v_fmac_f32 v130, v140, v140
    v_fmac_f32 v131, v141, v141
    v_mfma_f32_32x32x16_bf16 v[112:127], v[44:47], v[36:39], v[112:127]
    v_and_b32 v140, v29, v35
    v_lshlrev_b32 v141, 16, v35
    v_add_f32 v132, v132, v140
    v_add_f32 v133, v133, v141
    v_fmac_f32 v134, v140, v140
    v_fmac_f32 v135, v141, v141
    v_mfma_f32_32x32x16_bf16 v[144:159], v[40:43], v[160:163], v[144:159]
    s_waitcnt lgkmcnt(0)
    v_mfma_f32_32x32x16_bf16 v[64:79], v[56:59], v[48:51], v[64:79]
    v_and_b32 v140, v29, v48
    v_lshlrev_b32 v141, 16, v48
    v_add_f32 v128, v128, v140
    v_add_f32 v129, v129, v141
    v_fmac_f32 v130, v140, v140
    v_fmac_f32 v131, v141, v141
    v_mfma_f32_32x32x16_bf16 v[80:95], v[60:63], v[48:51], v[80:95]
    v_and_b32 v140, v29, v49
    v_lshlrev_b32 v141, 16, v49
    v_add_f32 v132, v132, v140
    v_add_f32 v133, v133, v141
    v_fmac_f32 v134, v140, v140
    v_fmac_f32 v135, v141, v141
    v_mfma_f32_32x32x16_bf16 v[96:111], v[56:59], v[52:55], v[96:111]
    v_and_b32 v140, v29, v50
    v_lshlrev_b32 v141, 16, v50
    v_add_f32 v128, v128, v140
    v_add_f32 v129, v129, v141
    v_fmac_f32 v130, v140, v140
    v_fmac_f32 v131, v141, v141
    v_mfma_f32_32x32x16_bf16 v[112:127], v[60:63], v[52:55], v[112:127]
    v_and_b32 v140, v29, v51
    v_lshlrev_b32 v141, 16, v51
    v_add_f32 v132, v132, v140
    v_add_f32 v133, v133, v141
    v_fmac_f32 v134, v140, v140
    v_fmac_f32 v135, v141, v141
    v_mfma_f32_32x32x16_bf16 v[144:159], v[56:59], v[160:163], v[144:159]
    s_add_u32 s42, s42, 49152
    s_mov_b32 s43, 49152
    s_cmp_eq_u32 s42, 147456
    s_cmov_b32 s42, 0
    s_cmov_b32 s43, 0xfffe8000
    v_add_u32 v16, s43, v16
    v_add_u32 v17, s43, v17
    v_add_u32 v18, s43, v18
    v_add_u32 v19, s43, v19
    v_add_u32 v20, s43, v20
    v_add_u32 v21, s43, v21
    v_add_u32 v22, s43, v22
    v_add_u32 v23, s43, v23
    v_add_u32 v24, s43, v24
    v_add_u32 v25, s43, v25
    s_add_u32 s40, s40, 1
    s_cmp_lt_u32 s40, 8
    s_cbranch_scc1 k1_kernel_ml_CT
    s_cmp_ge_u32 s24, 12
    s_cbranch_scc1 k1_kernel_hrole
    s_nop 15
    v_add_f32 v128, v128, v129
    v_add_f32 v132, v132, v133
    v_add_f32 v130, v130, v131
    v_add_f32 v134, v134, v135
    v_add_f32 v128, v128, v132
    v_add_f32 v132, v130, v134
    v_mov_b32 v32, v128
    s_nop 1
    v_permlane32_swap_b32 v128, v32
    v_add_f32 v128, v128, v32
    v_mov_b32 v33, v132
    s_nop 1
    v_permlane32_swap_b32 v132, v33
    v_add_f32 v132, v132, v33
    v_mul_f32 v128, 0x3b000000, v128
    v_mul_f32 v132, 0x3b000000, v132
    v_fma_f32 v132, -v128, v128, v132
    v_max_f32 v132, 0, v132
    v_cvt_pk_bf16_f32 v32, v128, v128
    v_lshlrev_b32 v128, 16, v32
    v_cvt_pk_bf16_f32 v33, v132, v132
    v_lshlrev_b32 v132, 16, v33
    v_add_f32 v132, 0x3727c5ac, v132
    v_cvt_pk_bf16_f32 v33, v132, v132
    v_lshlrev_b32 v132, 16, v33
    v_sqrt_f32 v132, v132
    s_nop 0
    v_cvt_pk_bf16_f32 v33, v132, v132
    v_lshlrev_b32 v132, 16, v33
    v_rcp_f32 v132, v132
    s_nop 0
    v_mul_f32 v133, v128, v132
    s_lshl_b32 s46, s34, 8
    v_lshl_add_u32 v32, v2, 3, s46
    ds_write_b64 v32, v[132:133] offset:0
    s_cmp_ge_u32 s21, 2
    s_cbranch_scc1 k1_kernel_nocs_qk
    s_lshl_b32 s46, s36, 7
    v_lshl_add_u32 v33, v2, 2, s46
    v_lshl_add_u32 v34, v3, 4, s46
    s_mov_b32 s46, 1
    s_mov_b32 s47, 1
    s_mov_b64 exec, s[46:47]
    ds_write_b128 v34, v[144:147] offset:2048
    ds_write_b128 v34, v[148:151] offset:2080
    ds_write_b128 v34, v[152:155] offset:2112
    ds_write_b128 v34, v[156:159] offset:2144
    s_mov_b64 exec, -1
k1_kernel_nocs_qk:
    s_waitcnt lgkmcnt(0)
    s_barrier
    v_lshlrev_b32 v40, 4, v1
    v_lshlrev_b32 v37, 4, v3
    s_lshl_b32 s48, s23, 3
    s_cmp_lt_u32 s24, 4
    s_mov_b32 s49, 1.0
    s_cmov_b32 s49, 0x3eb8aa3b
    s_mov_b32 s50, 0x200000
    s_cmov_b32 s50, 0x0
    s_mov_b32 s51, 4
    s_cmov_b32 s51, 0
    s_sub_u32 s51, s24, s51
    s_lshl_b32 s51, s51, 3
    s_mov_b32 s52, 0
k1_kernel_qkl:
    s_lshr_b32 s53, s52, 1
    s_xor_b32 s53, s53, s34
    s_and_b32 s54, s52, 1
    s_xor_b32 s54, s54, s36
    s_lshl_b32 s46, s53, 8
    v_lshl_add_u32 v36, v2, 3, s46
    ds_read_b64 v[32:33], v36 offset:0
    s_lshl_b32 s46, s54, 7
    v_add_u32 v38, s46, v37
    ds_read_b128 v[144:147], v38 offset:2048
    ds_read_b128 v[148:151], v38 offset:2080
    ds_read_b128 v[152:155], v38 offset:2112
    ds_read_b128 v[156:159], v38 offset:2144
    s_lshl_b32 s46, s52, 4
    s_set_gpr_idx_on s46, gpr_idx(SRC0)
    v_mov_b32 v176, v64
    v_mov_b32 v177, v65
    v_mov_b32 v178, v66
    v_mov_b32 v179, v67
    v_mov_b32 v180, v68
    v_mov_b32 v181, v69
    v_mov_b32 v182, v70
    v_mov_b32 v183, v71
    v_mov_b32 v184, v72
    v_mov_b32 v185, v73
    v_mov_b32 v186, v74
    v_mov_b32 v187, v75
    v_mov_b32 v188, v76
    v_mov_b32 v189, v77
    v_mov_b32 v190, v78
    v_mov_b32 v191, v79
    s_set_gpr_idx_off
    s_waitcnt lgkmcnt(0)
    v_mul_f32 v32, s49, v32
    v_mul_f32 v33, s49, v33
    v_mul_f32 v160, v33, v144
    v_mul_f32 v161, v33, v145
    v_mul_f32 v162, v33, v146
    v_mul_f32 v163, v33, v147
    v_mul_f32 v164, v33, v148
    v_mul_f32 v165, v33, v149
    v_mul_f32 v166, v33, v150
    v_mul_f32 v167, v33, v151
    v_mul_f32 v168, v33, v152
    v_mul_f32 v169, v33, v153
    v_mul_f32 v170, v33, v154
    v_mul_f32 v171, v33, v155
    v_mul_f32 v172, v33, v156
    v_mul_f32 v173, v33, v157
    v_mul_f32 v174, v33, v158
    v_mul_f32 v175, v33, v159
    v_fma_f32 v176, v176, v32, -v160
    v_fma_f32 v177, v177, v32, -v161
    v_fma_f32 v178, v178, v32, -v162
    v_fma_f32 v179, v179, v32, -v163
    v_fma_f32 v180, v180, v32, -v164
    v_fma_f32 v181, v181, v32, -v165
    v_fma_f32 v182, v182, v32, -v166
    v_fma_f32 v183, v183, v32, -v167
    v_fma_f32 v184, v184, v32, -v168
    v_fma_f32 v185, v185, v32, -v169
    v_fma_f32 v186, v186, v32, -v170
    v_fma_f32 v187, v187, v32, -v171
    v_fma_f32 v188, v188, v32, -v172
    v_fma_f32 v189, v189, v32, -v173
    v_fma_f32 v190, v190, v32, -v174
    v_fma_f32 v191, v191, v32, -v175
    v_cvt_pk_bf16_f32 v56, v176, v177
    v_cvt_pk_bf16_f32 v57, v178, v179
    v_cvt_pk_bf16_f32 v58, v180, v181
    v_cvt_pk_bf16_f32 v59, v182, v183
    v_cvt_pk_bf16_f32 v60, v184, v185
    v_cvt_pk_bf16_f32 v61, v186, v187
    v_cvt_pk_bf16_f32 v62, v188, v189
    v_cvt_pk_bf16_f32 v63, v190, v191
    s_lshl_b32 s46, s54, 1
    s_add_u32 s46, s46, s51
    s_lshl_b32 s46, s46, 16
    s_add_u32 s47, s48, s53
    s_lshl_b32 s47, s47, 10
    s_add_u32 s46, s46, s47
    s_add_u32 s46, s46, s50
    buffer_store_dwordx4 v[56:59], v40, s[12:15], s46 offen
    s_add_u32 s46, s46, 0x10000
    buffer_store_dwordx4 v[60:63], v40, s[12:15], s46 offen
    s_add_u32 s52, s52, 1
    s_cmp_lt_u32 s52, 4
    s_cbranch_scc1 k1_kernel_qkl
    s_endpgm
k1_kernel_hrole:
    s_nop 15
    v_add_f32 v128, v128, v129
    v_add_f32 v132, v132, v133
    v_add_f32 v130, v130, v131
    v_add_f32 v134, v134, v135
    v_add_f32 v128, v128, v132
    v_add_f32 v132, v130, v134
    v_mov_b32 v32, v128
    s_nop 1
    v_permlane32_swap_b32 v128, v32
    v_add_f32 v128, v128, v32
    v_mov_b32 v33, v132
    s_nop 1
    v_permlane32_swap_b32 v132, v33
    v_add_f32 v132, v132, v33
    v_mul_f32 v128, 0x3b000000, v128
    v_mul_f32 v132, 0x3b000000, v132
    v_fma_f32 v132, -v128, v128, v132
    v_max_f32 v132, 0, v132
    v_cvt_pk_bf16_f32 v32, v128, v128
    v_lshlrev_b32 v128, 16, v32
    v_cvt_pk_bf16_f32 v33, v132, v132
    v_lshlrev_b32 v132, 16, v33
    v_add_f32 v132, 0x3727c5ac, v132
    v_cvt_pk_bf16_f32 v33, v132, v132
    v_lshlrev_b32 v132, 16, v33
    v_sqrt_f32 v132, v132
    s_nop 0
    v_cvt_pk_bf16_f32 v33, v132, v132
    v_lshlrev_b32 v132, 16, v33
    v_rcp_f32 v132, v132
    s_nop 0
    v_mul_f32 v133, v128, v132
    s_lshl_b32 s46, s34, 8
    v_lshl_add_u32 v32, v2, 3, s46
    ds_write_b64 v32, v[132:133] offset:0
    s_cmp_ge_u32 s21, 2
    s_cbranch_scc1 k1_kernel_nocs_h
    s_lshl_b32 s46, s36, 7
    v_lshl_add_u32 v33, v2, 2, s46
    v_lshl_add_u32 v34, v3, 4, s46
    s_mov_b32 s46, 1
    s_mov_b32 s47, 1
    s_mov_b64 exec, s[46:47]
    ds_write_b128 v34, v[144:147] offset:2048
    ds_write_b128 v34, v[148:151] offset:2080
    ds_write_b128 v34, v[152:155] offset:2112
    ds_write_b128 v34, v[156:159] offset:2144
    s_mov_b64 exec, -1
    s_lshl_b32 s46, s36, 6
    s_add_u32 s46, s46, s26
    v_lshl_add_u32 v34, v2, 1, s46
    buffer_load_ushort v35, v34, s[16:19], 0 offen
    s_waitcnt vmcnt(0)
    v_lshlrev_b32 v35, 16, v35
    ds_write_b32 v33, v35 offset:2560
k1_kernel_nocs_h:
    s_waitcnt lgkmcnt(0)
    s_barrier
    v_lshlrev_b32 v40, 4, v1
    v_lshlrev_b32 v37, 4, v3
    s_lshl_b32 s48, s23, 3
    v_mov_b32 v46, 0xc0135761
    v_mov_b32 v47, 0xbdd2d3e8
    s_mov_b32 s52, 0
k1_kernel_hl:
    s_lshr_b32 s53, s52, 1
    s_xor_b32 s53, s53, s34
    s_and_b32 s54, s52, 1
    s_xor_b32 s54, s54, s36
    s_lshl_b32 s46, s53, 8
    v_lshl_add_u32 v36, v2, 3, s46
    ds_read_b64 v[32:33], v36 offset:0
    s_lshl_b32 s46, s54, 7
    v_add_u32 v38, s46, v37
    ds_read_b128 v[144:147], v38 offset:2048
    ds_read_b128 v[160:163], v38 offset:2560
    ds_read_b128 v[148:151], v38 offset:2080
    ds_read_b128 v[164:167], v38 offset:2592
    ds_read_b128 v[152:155], v38 offset:2112
    ds_read_b128 v[168:171], v38 offset:2624
    ds_read_b128 v[156:159], v38 offset:2144
    ds_read_b128 v[172:175], v38 offset:2656
    s_lshl_b32 s46, s52, 4
    s_set_gpr_idx_on s46, gpr_idx(SRC0)
    v_mov_b32 v176, v64
    v_mov_b32 v177, v65
    v_mov_b32 v178, v66
    v_mov_b32 v179, v67
    v_mov_b32 v180, v68
    v_mov_b32 v181, v69
    v_mov_b32 v182, v70
    v_mov_b32 v183, v71
    v_mov_b32 v184, v72
    v_mov_b32 v185, v73
    v_mov_b32 v186, v74
    v_mov_b32 v187, v75
    v_mov_b32 v188, v76
    v_mov_b32 v189, v77
    v_mov_b32 v190, v78
    v_mov_b32 v191, v79
    s_set_gpr_idx_off
    s_waitcnt lgkmcnt(0)
    v_fma_f32 v48, -v33, v144, v160
    v_fma_f32 v49, -v33, v145, v161
    v_fma_f32 v50, -v33, v146, v162
    v_fma_f32 v51, -v33, v147, v163
    v_fma_f32 v176, v176, v32, v48
    v_fma_f32 v177, v177, v32, v49
    v_fma_f32 v178, v178, v32, v50
    v_fma_f32 v179, v179, v32, v51
    v_mul_f32 v52, v176, v176
    v_mul_f32 v53, v177, v177
    v_mul_f32 v54, v178, v178
    v_mul_f32 v55, v179, v179
    v_fma_f32 v52, v52, v47, v46
    v_fma_f32 v53, v53, v47, v46
    v_fma_f32 v54, v54, v47, v46
    v_fma_f32 v55, v55, v47, v46
    v_mul_f32 v52, v52, v176
    v_mul_f32 v53, v53, v177
    v_mul_f32 v54, v54, v178
    v_mul_f32 v55, v55, v179
    v_exp_f32 v52, v52
    v_exp_f32 v53, v53
    v_exp_f32 v54, v54
    v_exp_f32 v55, v55
    v_add_f32 v52, 1.0, v52
    v_add_f32 v53, 1.0, v53
    v_add_f32 v54, 1.0, v54
    v_add_f32 v55, 1.0, v55
    v_rcp_f32 v52, v52
    v_rcp_f32 v53, v53
    v_rcp_f32 v54, v54
    v_rcp_f32 v55, v55
    v_mul_f32 v176, v176, v52
    v_mul_f32 v177, v177, v53
    v_mul_f32 v178, v178, v54
    v_mul_f32 v179, v179, v55
    v_fma_f32 v48, -v33, v148, v164
    v_fma_f32 v49, -v33, v149, v165
    v_fma_f32 v50, -v33, v150, v166
    v_fma_f32 v51, -v33, v151, v167
    v_fma_f32 v180, v180, v32, v48
    v_fma_f32 v181, v181, v32, v49
    v_fma_f32 v182, v182, v32, v50
    v_fma_f32 v183, v183, v32, v51
    v_mul_f32 v52, v180, v180
    v_mul_f32 v53, v181, v181
    v_mul_f32 v54, v182, v182
    v_mul_f32 v55, v183, v183
    v_fma_f32 v52, v52, v47, v46
    v_fma_f32 v53, v53, v47, v46
    v_fma_f32 v54, v54, v47, v46
    v_fma_f32 v55, v55, v47, v46
    v_mul_f32 v52, v52, v180
    v_mul_f32 v53, v53, v181
    v_mul_f32 v54, v54, v182
    v_mul_f32 v55, v55, v183
    v_exp_f32 v52, v52
    v_exp_f32 v53, v53
    v_exp_f32 v54, v54
    v_exp_f32 v55, v55
    v_add_f32 v52, 1.0, v52
    v_add_f32 v53, 1.0, v53
    v_add_f32 v54, 1.0, v54
    v_add_f32 v55, 1.0, v55
    v_rcp_f32 v52, v52
    v_rcp_f32 v53, v53
    v_rcp_f32 v54, v54
    v_rcp_f32 v55, v55
    v_mul_f32 v180, v180, v52
    v_mul_f32 v181, v181, v53
    v_mul_f32 v182, v182, v54
    v_mul_f32 v183, v183, v55
    v_fma_f32 v48, -v33, v152, v168
    v_fma_f32 v49, -v33, v153, v169
    v_fma_f32 v50, -v33, v154, v170
    v_fma_f32 v51, -v33, v155, v171
    v_fma_f32 v184, v184, v32, v48
    v_fma_f32 v185, v185, v32, v49
    v_fma_f32 v186, v186, v32, v50
    v_fma_f32 v187, v187, v32, v51
    v_mul_f32 v52, v184, v184
    v_mul_f32 v53, v185, v185
    v_mul_f32 v54, v186, v186
    v_mul_f32 v55, v187, v187
    v_fma_f32 v52, v52, v47, v46
    v_fma_f32 v53, v53, v47, v46
    v_fma_f32 v54, v54, v47, v46
    v_fma_f32 v55, v55, v47, v46
    v_mul_f32 v52, v52, v184
    v_mul_f32 v53, v53, v185
    v_mul_f32 v54, v54, v186
    v_mul_f32 v55, v55, v187
    v_exp_f32 v52, v52
    v_exp_f32 v53, v53
    v_exp_f32 v54, v54
    v_exp_f32 v55, v55
    v_add_f32 v52, 1.0, v52
    v_add_f32 v53, 1.0, v53
    v_add_f32 v54, 1.0, v54
    v_add_f32 v55, 1.0, v55
    v_rcp_f32 v52, v52
    v_rcp_f32 v53, v53
    v_rcp_f32 v54, v54
    v_rcp_f32 v55, v55
    v_mul_f32 v184, v184, v52
    v_mul_f32 v185, v185, v53
    v_mul_f32 v186, v186, v54
    v_mul_f32 v187, v187, v55
    v_fma_f32 v48, -v33, v156, v172
    v_fma_f32 v49, -v33, v157, v173
    v_fma_f32 v50, -v33, v158, v174
    v_fma_f32 v51, -v33, v159, v175
    v_fma_f32 v188, v188, v32, v48
    v_fma_f32 v189, v189, v32, v49
    v_fma_f32 v190, v190, v32, v50
    v_fma_f32 v191, v191, v32, v51
    v_mul_f32 v52, v188, v188
    v_mul_f32 v53, v189, v189
    v_mul_f32 v54, v190, v190
    v_mul_f32 v55, v191, v191
    v_fma_f32 v52, v52, v47, v46
    v_fma_f32 v53, v53, v47, v46
    v_fma_f32 v54, v54, v47, v46
    v_fma_f32 v55, v55, v47, v46
    v_mul_f32 v52, v52, v188
    v_mul_f32 v53, v53, v189
    v_mul_f32 v54, v54, v190
    v_mul_f32 v55, v55, v191
    v_exp_f32 v52, v52
    v_exp_f32 v53, v53
    v_exp_f32 v54, v54
    v_exp_f32 v55, v55
    v_add_f32 v52, 1.0, v52
    v_add_f32 v53, 1.0, v53
    v_add_f32 v54, 1.0, v54
    v_add_f32 v55, 1.0, v55
    v_rcp_f32 v52, v52
    v_rcp_f32 v53, v53
    v_rcp_f32 v54, v54
    v_rcp_f32 v55, v55
    v_mul_f32 v188, v188, v52
    v_mul_f32 v189, v189, v53
    v_mul_f32 v190, v190, v54
    v_mul_f32 v191, v191, v55
    v_cvt_pk_bf16_f32 v56, v176, v177
    v_cvt_pk_bf16_f32 v57, v178, v179
    v_cvt_pk_bf16_f32 v58, v180, v181
    v_cvt_pk_bf16_f32 v59, v182, v183
    v_cvt_pk_bf16_f32 v60, v184, v185
    v_cvt_pk_bf16_f32 v61, v186, v187
    v_cvt_pk_bf16_f32 v62, v188, v189
    v_cvt_pk_bf16_f32 v63, v190, v191
    s_add_u32 s47, s48, s53
    s_mul_i32 s47, s47, 112
    s_lshr_b32 s46, s26, 5
    s_add_u32 s47, s47, s46
    s_lshl_b32 s46, s54, 1
    s_add_u32 s47, s47, s46
    s_lshl_b32 s47, s47, 10
    s_add_u32 s47, s47, 0x1000000
    buffer_store_dwordx4 v[56:59], v40, s[12:15], s47 offen
    buffer_store_dwordx4 v[60:63], v40, s[12:15], s47 offen offset:1024
    s_add_u32 s52, s52, 1
    s_cmp_lt_u32 s52, 4
    s_cbranch_scc1 k1_kernel_hl
    s_endpgm
k1_kernel_vrole:
    s_add_u32 s46, s29, s39
    s_add_u32 m0, s46, 0
    s_add_u32 s46, s27, 0
    buffer_load_dwordx4 v26, s[4:7], s46 offen lds
    s_add_u32 s46, s29, s39
    s_add_u32 m0, s46, 1024
    s_add_u32 s46, s27, 8192
    buffer_load_dwordx4 v27, s[4:7], s46 offen lds
    s_add_u32 s46, s29, s39
    s_add_u32 m0, s46, 2048
    s_add_u32 s46, s27, 16384
    buffer_load_dwordx4 v26, s[4:7], s46 offen lds
    s_add_u32 s46, s29, s39
    s_add_u32 m0, s46, 3072
    s_add_u32 s46, s27, 24576
    buffer_load_dwordx4 v27, s[4:7], s46 offen lds
    s_add_u32 m0, s38, s39
    s_nop 0
    buffer_load_dwordx4 v28, s[8:11], s28 offen lds
    s_add_u32 s46, s38, s39
    s_add_u32 m0, s46, 1024
    s_add_u32 s46, s28, s30
    buffer_load_dwordx4 v28, s[8:11], s46 offen lds
    s_add_u32 s27, s27, 128
    s_add_u32 s28, s28, s33
    s_add_u32 s39, s39, 49152
    s_cmp_eq_u32 s39, 147456
    s_cmov_b32 s39, 0
    s_add_u32 s46, s29, s39
    s_add_u32 m0, s46, 0
    s_add_u32 s46, s27, 0
    buffer_load_dwordx4 v26, s[4:7], s46 offen lds
    s_add_u32 s46, s29, s39
    s_add_u32 m0, s46, 1024
    s_add_u32 s46, s27, 8192
    buffer_load_dwordx4 v27, s[4:7], s46 offen lds
    s_add_u32 s46, s29, s39
    s_add_u32 m0, s46, 2048
    s_add_u32 s46, s27, 16384
    buffer_load_dwordx4 v26, s[4:7], s46 offen lds
    s_add_u32 s46, s29, s39
    s_add_u32 m0, s46, 3072
    s_add_u32 s46, s27, 24576
    buffer_load_dwordx4 v27, s[4:7], s46 offen lds
    s_add_u32 m0, s38, s39
    s_nop 0
    buffer_load_dwordx4 v28, s[8:11], s28 offen lds
    s_add_u32 s46, s38, s39
    s_add_u32 m0, s46, 1024
    s_add_u32 s46, s28, s30
    buffer_load_dwordx4 v28, s[8:11], s46 offen lds
    s_add_u32 s27, s27, 128
    s_add_u32 s28, s28, s33
    s_add_u32 s39, s39, 49152
    s_cmp_eq_u32 s39, 147456
    s_cmov_b32 s39, 0
    s_mov_b32 s40, 0
k1_kernel_ml_C:
    s_cmp_lt_u32 s40, 7
    s_cbranch_scc1 k1_kernel_ml_C_w
    s_waitcnt vmcnt(0)
k1_kernel_ml_C_w:
    s_waitcnt vmcnt(6)
    s_barrier
    s_cmp_ge_u32 s40, 6
    s_cbranch_scc1 k1_kernel_ml_C_nd
    s_add_u32 s46, s29, s39
    s_add_u32 m0, s46, 0
    s_add_u32 s46, s27, 0
    buffer_load_dwordx4 v26, s[4:7], s46 offen lds
    s_add_u32 s46, s29, s39
    s_add_u32 m0, s46, 1024
    s_add_u32 s46, s27, 8192
    buffer_load_dwordx4 v27, s[4:7], s46 offen lds
    s_add_u32 s46, s29, s39
    s_add_u32 m0, s46, 2048
    s_add_u32 s46, s27, 16384
    buffer_load_dwordx4 v26, s[4:7], s46 offen lds
    s_add_u32 s46, s29, s39
    s_add_u32 m0, s46, 3072
    s_add_u32 s46, s27, 24576
    buffer_load_dwordx4 v27, s[4:7], s46 offen lds
    s_add_u32 m0, s38, s39
    s_nop 0
    buffer_load_dwordx4 v28, s[8:11], s28 offen lds
    s_add_u32 s46, s38, s39
    s_add_u32 m0, s46, 1024
    s_add_u32 s46, s28, s30
    buffer_load_dwordx4 v28, s[8:11], s46 offen lds
    s_add_u32 s27, s27, 128
    s_add_u32 s28, s28, s33
    s_add_u32 s39, s39, 49152
    s_cmp_eq_u32 s39, 147456
    s_cmov_b32 s39, 0
k1_kernel_ml_C_nd:
    ds_read_b128 v[32:35], v16
    ds_read_b128 v[36:39], v20
    ds_read_b64_tr_b16 v[40:41], v24 offset:0
    ds_read_b64_tr_b16 v[42:43], v24 offset:1024
    ds_read_b64_tr_b16 v[44:45], v25 offset:0
    ds_read_b64_tr_b16 v[46:47], v25 offset:1024
    ds_read_b128 v[48:51], v17
    ds_read_b128 v[52:55], v21
    ds_read_b64_tr_b16 v[56:57], v24 offset:4096
    ds_read_b64_tr_b16 v[58:59], v24 offset:5120
    ds_read_b64_tr_b16 v[60:61], v25 offset:4096
    ds_read_b64_tr_b16 v[62:63], v25 offset:5120
    s_waitcnt lgkmcnt(6)
    v_mfma_f32_32x32x16_bf16 v[64:79], v[32:35], v[40:43], v[64:79]
    v_and_b32 v140, v29, v32
    v_lshlrev_b32 v141, 16, v32
    v_add_f32 v128, v128, v140
    v_add_f32 v129, v129, v141
    v_fmac_f32 v130, v140, v140
    v_fmac_f32 v131, v141, v141
    v_mfma_f32_32x32x16_bf16 v[80:95], v[32:35], v[44:47], v[80:95]
    v_and_b32 v140, v29, v33
    v_lshlrev_b32 v141, 16, v33
    v_add_f32 v132, v132, v140
    v_add_f32 v133, v133, v141
    v_fmac_f32 v134, v140, v140
    v_fmac_f32 v135, v141, v141
    v_mfma_f32_32x32x16_bf16 v[96:111], v[36:39], v[40:43], v[96:111]
    v_and_b32 v140, v29, v34
    v_lshlrev_b32 v141, 16, v34
    v_add_f32 v128, v128, v140
    v_add_f32 v129, v129, v141
    v_fmac_f32 v130, v140, v140
    v_fmac_f32 v131, v141, v141
    v_mfma_f32_32x32x16_bf16 v[112:127], v[36:39], v[44:47], v[112:127]
    v_and_b32 v140, v29, v35
    v_lshlrev_b32 v141, 16, v35
    v_add_f32 v132, v132, v140
    v_add_f32 v133, v133, v141
    v_fmac_f32 v134, v140, v140
    v_fmac_f32 v135, v141, v141
    v_mfma_f32_32x32x16_bf16 v[144:159], v[40:43], v[160:163], v[144:159]
    ds_read_b128 v[32:35], v18
    ds_read_b128 v[36:39], v22
    ds_read_b64_tr_b16 v[40:41], v24 offset:8192
    ds_read_b64_tr_b16 v[42:43], v24 offset:9216
    ds_read_b64_tr_b16 v[44:45], v25 offset:8192
    ds_read_b64_tr_b16 v[46:47], v25 offset:9216
    s_waitcnt lgkmcnt(6)
    v_mfma_f32_32x32x16_bf16 v[64:79], v[48:51], v[56:59], v[64:79]
    v_and_b32 v140, v29, v48
    v_lshlrev_b32 v141, 16, v48
    v_add_f32 v128, v128, v140
    v_add_f32 v129, v129, v141
    v_fmac_f32 v130, v140, v140
    v_fmac_f32 v131, v141, v141
    v_mfma_f32_32x32x16_bf16 v[80:95], v[48:51], v[60:63], v[80:95]
    v_and_b32 v140, v29, v49
    v_lshlrev_b32 v141, 16, v49
    v_add_f32 v132, v132, v140
    v_add_f32 v133, v133, v141
    v_fmac_f32 v134, v140, v140
    v_fmac_f32 v135, v141, v141
    v_mfma_f32_32x32x16_bf16 v[96:111], v[52:55], v[56:59], v[96:111]
    v_and_b32 v140, v29, v50
    v_lshlrev_b32 v141, 16, v50
    v_add_f32 v128, v128, v140
    v_add_f32 v129, v129, v141
    v_fmac_f32 v130, v140, v140
    v_fmac_f32 v131, v141, v141
    v_mfma_f32_32x32x16_bf16 v[112:127], v[52:55], v[60:63], v[112:127]
    v_and_b32 v140, v29, v51
    v_lshlrev_b32 v141, 16, v51
    v_add_f32 v132, v132, v140
    v_add_f32 v133, v133, v141
    v_fmac_f32 v134, v140, v140
    v_fmac_f32 v135, v141, v141
    v_mfma_f32_32x32x16_bf16 v[144:159], v[56:59], v[160:163], v[144:159]
    ds_read_b128 v[48:51], v19
    ds_read_b128 v[52:55], v23
    ds_read_b64_tr_b16 v[56:57], v24 offset:12288
    ds_read_b64_tr_b16 v[58:59], v24 offset:13312
    ds_read_b64_tr_b16 v[60:61], v25 offset:12288
    ds_read_b64_tr_b16 v[62:63], v25 offset:13312
    s_waitcnt lgkmcnt(6)
    v_mfma_f32_32x32x16_bf16 v[64:79], v[32:35], v[40:43], v[64:79]
    v_and_b32 v140, v29, v32
    v_lshlrev_b32 v141, 16, v32
    v_add_f32 v128, v128, v140
    v_add_f32 v129, v129, v141
    v_fmac_f32 v130, v140, v140
    v_fmac_f32 v131, v141, v141
    v_mfma_f32_32x32x16_bf16 v[80:95], v[32:35], v[44:47], v[80:95]
    v_and_b32 v140, v29, v33
    v_lshlrev_b32 v141, 16, v33
    v_add_f32 v132, v132, v140
    v_add_f32 v133, v133, v141
    v_fmac_f32 v134, v140, v140
    v_fmac_f32 v135, v141, v141
    v_mfma_f32_32x32x16_bf16 v[96:111], v[36:39], v[40:43], v[96:111]
    v_and_b32 v140, v29, v34
    v_lshlrev_b32 v141, 16, v34
    v_add_f32 v128, v128, v140
    v_add_f32 v129, v129, v141
    v_fmac_f32 v130, v140, v140
    v_fmac_f32 v131, v141, v141
    v_mfma_f32_32x32x16_bf16 v[112:127], v[36:39], v[44:47], v[112:127]
    v_and_b32 v140, v29, v35
    v_lshlrev_b32 v141, 16, v35
    v_add_f32 v132, v132, v140
    v_add_f32 v133, v133, v141
    v_fmac_f32 v134, v140, v140
    v_fmac_f32 v135, v141, v141
    v_mfma_f32_32x32x16_bf16 v[144:159], v[40:43], v[160:163], v[144:159]
    s_waitcnt lgkmcnt(0)
    v_mfma_f32_32x32x16_bf16 v[64:79], v[48:51], v[56:59], v[64:79]
    v_and_b32 v140, v29, v48
    v_lshlrev_b32 v141, 16, v48
    v_add_f32 v128, v128, v140
    v_add_f32 v129, v129, v141
    v_fmac_f32 v130, v140, v140
    v_fmac_f32 v131, v141, v141
    v_mfma_f32_32x32x16_bf16 v[80:95], v[48:51], v[60:63], v[80:95]
    v_and_b32 v140, v29, v49
    v_lshlrev_b32 v141, 16, v49
    v_add_f32 v132, v132, v140
    v_add_f32 v133, v133, v141
    v_fmac_f32 v134, v140, v140
    v_fmac_f32 v135, v141, v141
    v_mfma_f32_32x32x16_bf16 v[96:111], v[52:55], v[56:59], v[96:111]
    v_and_b32 v140, v29, v50
    v_lshlrev_b32 v141, 16, v50
    v_add_f32 v128, v128, v140
    v_add_f32 v129, v129, v141
    v_fmac_f32 v130, v140, v140
    v_fmac_f32 v131, v141, v141
    v_mfma_f32_32x32x16_bf16 v[112:127], v[52:55], v[60:63], v[112:127]
    v_and_b32 v140, v29, v51
    v_lshlrev_b32 v141, 16, v51
    v_add_f32 v132, v132, v140
    v_add_f32 v133, v133, v141
    v_fmac_f32 v134, v140, v140
    v_fmac_f32 v135, v141, v141
    v_mfma_f32_32x32x16_bf16 v[144:159], v[56:59], v[160:163], v[144:159]
    s_add_u32 s42, s42, 49152
    s_mov_b32 s43, 49152
    s_cmp_eq_u32 s42, 147456
    s_cmov_b32 s42, 0
    s_cmov_b32 s43, 0xfffe8000
    v_add_u32 v16, s43, v16
    v_add_u32 v17, s43, v17
    v_add_u32 v18, s43, v18
    v_add_u32 v19, s43, v19
    v_add_u32 v20, s43, v20
    v_add_u32 v21, s43, v21
    v_add_u32 v22, s43, v22
    v_add_u32 v23, s43, v23
    v_add_u32 v24, s43, v24
    v_add_u32 v25, s43, v25
    s_add_u32 s40, s40, 1
    s_cmp_lt_u32 s40, 8
    s_cbranch_scc1 k1_kernel_ml_C
    s_nop 15
    v_add_f32 v128, v128, v129
    v_add_f32 v132, v132, v133
    v_add_f32 v130, v130, v131
    v_add_f32 v134, v134, v135
    v_add_f32 v128, v128, v132
    v_add_f32 v132, v130, v134
    v_mov_b32 v32, v128
    s_nop 1
    v_permlane32_swap_b32 v128, v32
    v_add_f32 v128, v128, v32
    v_mov_b32 v33, v132
    s_nop 1
    v_permlane32_swap_b32 v132, v33
    v_add_f32 v132, v132, v33
    v_mul_f32 v128, 0x3b000000, v128
    v_mul_f32 v132, 0x3b000000, v132
    v_fma_f32 v132, -v128, v128, v132
    v_max_f32 v132, 0, v132
    v_cvt_pk_bf16_f32 v32, v128, v128
    v_lshlrev_b32 v128, 16, v32
    v_cvt_pk_bf16_f32 v33, v132, v132
    v_lshlrev_b32 v132, 16, v33
    v_add_f32 v132, 0x3727c5ac, v132
    v_cvt_pk_bf16_f32 v33, v132, v132
    v_lshlrev_b32 v132, 16, v33
    v_sqrt_f32 v132, v132
    s_nop 0
    v_cvt_pk_bf16_f32 v33, v132, v132
    v_lshlrev_b32 v132, 16, v33
    v_rcp_f32 v132, v132
    s_nop 0
    v_mul_f32 v133, v128, v132
    s_lshl_b32 s46, s34, 8
    v_lshl_add_u32 v32, v2, 3, s46
    ds_write_b64 v32, v[132:133] offset:0
    s_cmp_ge_u32 s21, 2
    s_cbranch_scc1 k1_kernel_nocs_v
    s_lshl_b32 s46, s36, 7
    v_lshl_add_u32 v33, v2, 2, s46
    v_lshl_add_u32 v34, v3, 4, s46
    s_mov_b32 s46, 1
    s_mov_b32 s47, 1
    s_mov_b64 exec, s[46:47]
    ds_write_b128 v34, v[144:147] offset:2048
    ds_write_b128 v34, v[148:151] offset:2080
    ds_write_b128 v34, v[152:155] offset:2112
    ds_write_b128 v34, v[156:159] offset:2144
    s_mov_b64 exec, -1
k1_kernel_nocs_v:
    s_waitcnt lgkmcnt(0)
    s_barrier
    v_lshlrev_b32 v37, 5, v3
    v_lshrrev_b32 v40, 4, v2
    v_lshlrev_b32 v40, 16, v40
    v_lshl_add_u32 v40, v3, 8, v40
    v_and_b32 v41, 15, v2
    v_lshl_add_u32 v40, v41, 4, v40
    s_lshl_b32 s48, s23, 3
    s_sub_u32 s51, s24, 8
    s_lshl_b32 s51, s51, 3
    s_mov_b32 s52, 0
k1_kernel_vl:
    s_lshr_b32 s53, s52, 1
    s_xor_b32 s53, s53, s34
    s_and_b32 s54, s52, 1
    s_xor_b32 s54, s54, s36
    s_lshl_b32 s46, s54, 7
    v_lshl_add_u32 v36, v2, 2, s46
    ds_read_b32 v32, v36 offset:2048
    s_lshl_b32 s46, s53, 8
    v_add_u32 v38, s46, v37
    ds_read_b128 v[144:147], v38 offset:0
    ds_read_b128 v[148:151], v38 offset:16
    ds_read_b128 v[152:155], v38 offset:64
    ds_read_b128 v[156:159], v38 offset:80
    ds_read_b128 v[160:163], v38 offset:128
    ds_read_b128 v[164:167], v38 offset:144
    ds_read_b128 v[168:171], v38 offset:192
    ds_read_b128 v[172:175], v38 offset:208
    s_lshl_b32 s46, s52, 4
    s_set_gpr_idx_on s46, gpr_idx(SRC0)
    v_mov_b32 v192, v64
    v_mov_b32 v193, v65
    v_mov_b32 v194, v66
    v_mov_b32 v195, v67
    v_mov_b32 v196, v68
    v_mov_b32 v197, v69
    v_mov_b32 v198, v70
    v_mov_b32 v199, v71
    v_mov_b32 v200, v72
    v_mov_b32 v201, v73
    v_mov_b32 v202, v74
    v_mov_b32 v203, v75
    v_mov_b32 v204, v76
    v_mov_b32 v205, v77
    v_mov_b32 v206, v78
    v_mov_b32 v207, v79
    s_set_gpr_idx_off
    s_waitcnt lgkmcnt(0)
    v_mul_f32 v176, v145, v32
    v_mul_f32 v177, v147, v32
    v_mul_f32 v178, v149, v32
    v_mul_f32 v179, v151, v32
    v_mul_f32 v180, v153, v32
    v_mul_f32 v181, v155, v32
    v_mul_f32 v182, v157, v32
    v_mul_f32 v183, v159, v32
    v_mul_f32 v184, v161, v32
    v_mul_f32 v185, v163, v32
    v_mul_f32 v186, v165, v32
    v_mul_f32 v187, v167, v32
    v_mul_f32 v188, v169, v32
    v_mul_f32 v189, v171, v32
    v_mul_f32 v190, v173, v32
    v_mul_f32 v191, v175, v32
    v_fma_f32 v192, v192, v144, -v176
    v_fma_f32 v193, v193, v146, -v177
    v_fma_f32 v194, v194, v148, -v178
    v_fma_f32 v195, v195, v150, -v179
    v_fma_f32 v196, v196, v152, -v180
    v_fma_f32 v197, v197, v154, -v181
    v_fma_f32 v198, v198, v156, -v182
    v_fma_f32 v199, v199, v158, -v183
    v_fma_f32 v200, v200, v160, -v184
    v_fma_f32 v201, v201, v162, -v185
    v_fma_f32 v202, v202, v164, -v186
    v_fma_f32 v203, v203, v166, -v187
    v_fma_f32 v204, v204, v168, -v188
    v_fma_f32 v205, v205, v170, -v189
    v_fma_f32 v206, v206, v172, -v190
    v_fma_f32 v207, v207, v174, -v191
    v_cvt_pk_bf16_f32 v56, v192, v193
    v_cvt_pk_bf16_f32 v57, v194, v195
    v_cvt_pk_bf16_f32 v58, v196, v197
    v_cvt_pk_bf16_f32 v59, v198, v199
    v_cvt_pk_bf16_f32 v60, v200, v201
    v_cvt_pk_bf16_f32 v61, v202, v203
    v_cvt_pk_bf16_f32 v62, v204, v205
    v_cvt_pk_bf16_f32 v63, v206, v207
    s_lshl_b32 s46, s54, 1
    s_add_u32 s46, s46, s51
    s_lshl_b32 s46, s46, 16
    s_add_u32 s47, s48, s53
    s_lshl_b32 s47, s47, 10
    s_add_u32 s46, s46, s47
    s_add_u32 s46, s46, 0x400000
    buffer_store_dwordx4 v[56:59], v40, s[12:15], s46 offen
    buffer_store_dwordx4 v[60:63], v40, s[12:15], s46 offen offset:512
    s_add_u32 s52, s52, 1
    s_cmp_lt_u32 s52, 4
    s_cbranch_scc1 k1_kernel_vl
    s_endpgm
k1_kernel_transposer:
    s_sub_u32 s40, s2, 208
    s_cmp_ge_u32 s40, 28
    s_mov_b32 s8, s72
    s_cmov_b32 s8, s70
    s_mov_b32 s9, s73
    s_cmov_b32 s9, s71
    s_mov_b32 s10, 0x1C0000
    s_cmov_b32 s10, 0x80000
    s_mov_b32 s41, 0
    s_cmov_b32 s41, 28
    s_mov_b32 s42, 0xa00000
    s_cmov_b32 s42, 0xc00000
    s_mov_b32 s43, 112
    s_cmov_b32 s43, 32
    s_and_b32 s9, s9, 0xffff
    s_mov_b32 s11, 0x00020000
    s_sub_u32 s40, s40, s41
    s_and_b32 s21, s20, 3
    s_lshr_b32 s22, s20, 2
    v_lshrrev_b32 v4, 5, v1
    v_and_b32 v5, 31, v1
    v_lshlrev_b32 v6, 2, v4
    v_xor_b32 v6, v5, v6
    v_lshlrev_b32 v6, 4, v6
    v_lshl_add_u32 v6, v4, 10, v6
    v_xor_b32 v7, 128, v6
    s_lshl_b32 s44, s40, 6
    s_lshl_b32 s45, s21, 4
    s_add_u32 s44, s44, s45
    s_lshl_b32 s44, s44, 10
    s_lshl_b32 s45, s22, 9
    s_add_u32 s44, s44, s45
    s_lshl_b32 s45, s20, 13
    s_add_u32 m0, s45, 0
    s_add_u32 s46, s44, 0
    buffer_load_dwordx4 v6, s[8:11], s46 offen lds
    s_add_u32 m0, s45, 1024
    s_add_u32 s46, s44, 2048
    buffer_load_dwordx4 v7, s[8:11], s46 offen lds
    s_add_u32 m0, s45, 2048
    s_add_u32 s46, s44, 4096
    buffer_load_dwordx4 v6, s[8:11], s46 offen lds
    s_add_u32 m0, s45, 3072
    s_add_u32 s46, s44, 6144
    buffer_load_dwordx4 v7, s[8:11], s46 offen lds
    s_add_u32 m0, s45, 4096
    s_add_u32 s46, s44, 8192
    buffer_load_dwordx4 v6, s[8:11], s46 offen lds
    s_add_u32 m0, s45, 5120
    s_add_u32 s46, s44, 10240
    buffer_load_dwordx4 v7, s[8:11], s46 offen lds
    s_add_u32 m0, s45, 6144
    s_add_u32 s46, s44, 12288
    buffer_load_dwordx4 v6, s[8:11], s46 offen lds
    s_add_u32 m0, s45, 7168
    s_add_u32 s46, s44, 14336
    buffer_load_dwordx4 v7, s[8:11], s46 offen lds
    v_lshrrev_b32 v8, 5, v1
    v_bfe_u32 v9, v1, 4, 1
    v_bfe_u32 v10, v1, 2, 2
    v_and_b32 v11, 3, v1
    v_lshl_add_u32 v12, v8, 2, v10
    v_lshlrev_b32 v12, 9, v12
    v_add_u32 v12, s45, v12
    v_lshl_add_u32 v12, v9, 5, v12
    v_lshl_add_u32 v12, v11, 3, v12
    v_xor_b32 v13, 0, v10
    v_lshl_add_u32 v16, v13, 6, v12
    v_xor_b32 v13, 1, v10
    v_lshl_add_u32 v17, v13, 6, v12
    v_xor_b32 v13, 2, v10
    v_lshl_add_u32 v18, v13, 6, v12
    v_xor_b32 v13, 3, v10
    v_lshl_add_u32 v19, v13, 6, v12
    v_lshlrev_b32 v14, 4, v1
    s_lshl_b32 s47, s40, 2
    s_add_u32 s47, s47, s21
    s_lshl_b32 s49, s22, 3
    s_waitcnt vmcnt(0)
    ds_read_b64_tr_b16 v[32:33], v16 offset:0
    ds_read_b64_tr_b16 v[34:35], v16 offset:4096
    ds_read_b64_tr_b16 v[36:37], v17 offset:0
    ds_read_b64_tr_b16 v[38:39], v17 offset:4096
    ds_read_b64_tr_b16 v[40:41], v18 offset:0
    ds_read_b64_tr_b16 v[42:43], v18 offset:4096
    ds_read_b64_tr_b16 v[44:45], v19 offset:0
    ds_read_b64_tr_b16 v[46:47], v19 offset:4096
    ds_read_b64_tr_b16 v[48:49], v16 offset:256
    ds_read_b64_tr_b16 v[50:51], v16 offset:4352
    ds_read_b64_tr_b16 v[52:53], v17 offset:256
    ds_read_b64_tr_b16 v[54:55], v17 offset:4352
    ds_read_b64_tr_b16 v[56:57], v18 offset:256
    ds_read_b64_tr_b16 v[58:59], v18 offset:4352
    ds_read_b64_tr_b16 v[60:61], v19 offset:256
    ds_read_b64_tr_b16 v[62:63], v19 offset:4352
    s_add_u32 s48, s49, 0
    s_mul_i32 s48, s48, s43
    s_add_u32 s48, s48, s47
    s_lshl_b32 s48, s48, 10
    s_add_u32 s48, s48, s42
    s_waitcnt lgkmcnt(14)
    buffer_store_dwordx4 v[32:35], v14, s[12:15], s48 offen
    s_add_u32 s48, s49, 1
    s_mul_i32 s48, s48, s43
    s_add_u32 s48, s48, s47
    s_lshl_b32 s48, s48, 10
    s_add_u32 s48, s48, s42
    s_waitcnt lgkmcnt(12)
    buffer_store_dwordx4 v[36:39], v14, s[12:15], s48 offen
    s_add_u32 s48, s49, 2
    s_mul_i32 s48, s48, s43
    s_add_u32 s48, s48, s47
    s_lshl_b32 s48, s48, 10
    s_add_u32 s48, s48, s42
    s_waitcnt lgkmcnt(10)
    buffer_store_dwordx4 v[40:43], v14, s[12:15], s48 offen
    s_add_u32 s48, s49, 3
    s_mul_i32 s48, s48, s43
    s_add_u32 s48, s48, s47
    s_lshl_b32 s48, s48, 10
    s_add_u32 s48, s48, s42
    s_waitcnt lgkmcnt(8)
    buffer_store_dwordx4 v[44:47], v14, s[12:15], s48 offen
    s_add_u32 s48, s49, 4
    s_mul_i32 s48, s48, s43
    s_add_u32 s48, s48, s47
    s_lshl_b32 s48, s48, 10
    s_add_u32 s48, s48, s42
    s_waitcnt lgkmcnt(6)
    buffer_store_dwordx4 v[48:51], v14, s[12:15], s48 offen
    s_add_u32 s48, s49, 5
    s_mul_i32 s48, s48, s43
    s_add_u32 s48, s48, s47
    s_lshl_b32 s48, s48, 10
    s_add_u32 s48, s48, s42
    s_waitcnt lgkmcnt(4)
    buffer_store_dwordx4 v[52:55], v14, s[12:15], s48 offen
    s_add_u32 s48, s49, 6
    s_mul_i32 s48, s48, s43
    s_add_u32 s48, s48, s47
    s_lshl_b32 s48, s48, 10
    s_add_u32 s48, s48, s42
    s_waitcnt lgkmcnt(2)
    buffer_store_dwordx4 v[56:59], v14, s[12:15], s48 offen
    s_add_u32 s48, s49, 7
    s_mul_i32 s48, s48, s43
    s_add_u32 s48, s48, s47
    s_lshl_b32 s48, s48, 10
    s_add_u32 s48, s48, s42
    s_waitcnt lgkmcnt(0)
    buffer_store_dwordx4 v[60:63], v14, s[12:15], s48 offen
k1_kernel_exit:
    s_endpgm
.globl k2_kernel
.p2align 8
.type k2_kernel,@function
k2_kernel:
    s_cmp_ge_u32 s2, 256
    s_cbranch_scc1 k2_kernel_exit
    s_load_dwordx2 s[66:67], s[0:1], 80
    s_load_dwordx2 s[68:69], s[0:1], 56
    v_and_b32 v1, 63, v0
    v_lshrrev_b32 v2, 6, v0
    s_nop 0
    v_readfirstlane_b32 s20, v2
    v_lshlrev_b32 v3, 4, v1
    s_and_b32 s21, s2, 31
    s_lshr_b32 s22, s2, 5
    s_waitcnt lgkmcnt(0)
    s_mov_b32 s12, s66
    s_and_b32 s13, s67, 0xffff
    s_mov_b32 s14, 0x10000000
    s_mov_b32 s15, 0x00020000
    s_mov_b32 s16, s68
    s_and_b32 s17, s69, 0xffff
    s_mov_b32 s18, 0x400
    s_mov_b32 s19, 0x00020000
    s_cmp_ge_u32 s20, 8
    s_cbranch_scc1 k2_kernel_ffn
    s_lshl_b32 s23, s21, 16
    s_lshl_b32 s24, s20, 10
    s_add_u32 s25, s23, s24
    s_add_u32 s26, s25, 0x200000
    s_add_u32 s27, s25, 0x400000
    s_lshl_b32 s29, s22, 3
    s_add_u32 s29, s29, s20
    s_lshl_b32 s30, s29, 10
    s_add_u32 s30, s30, s23
    s_add_u32 s30, s30, 0x0
    buffer_load_dwordx4 v[4:7], v3, s[12:15], s30 offen
    s_add_u32 m0, s24, 0
    s_add_u32 s28, s26, 0
    buffer_load_dwordx4 v3, s[12:15], s28 offen lds
    s_add_u32 m0, s24, 65536
    s_add_u32 s28, s27, 0
    buffer_load_dwordx4 v3, s[12:15], s28 offen lds
    s_add_u32 m0, s24, 8192
    s_add_u32 s28, s26, 8192
    buffer_load_dwordx4 v3, s[12:15], s28 offen lds
    s_add_u32 m0, s24, 73728
    s_add_u32 s28, s27, 8192
    buffer_load_dwordx4 v3, s[12:15], s28 offen lds
    s_add_u32 m0, s24, 16384
    s_add_u32 s28, s26, 16384
    buffer_load_dwordx4 v3, s[12:15], s28 offen lds
    s_add_u32 m0, s24, 81920
    s_add_u32 s28, s27, 16384
    buffer_load_dwordx4 v3, s[12:15], s28 offen lds
    s_add_u32 m0, s24, 24576
    s_add_u32 s28, s26, 24576
    buffer_load_dwordx4 v3, s[12:15], s28 offen lds
    s_add_u32 m0, s24, 90112
    s_add_u32 s28, s27, 24576
    buffer_load_dwordx4 v3, s[12:15], s28 offen lds
    s_add_u32 m0, s24, 32768
    s_add_u32 s28, s26, 32768
    buffer_load_dwordx4 v3, s[12:15], s28 offen lds
    s_add_u32 m0, s24, 98304
    s_add_u32 s28, s27, 32768
    buffer_load_dwordx4 v3, s[12:15], s28 offen lds
    s_add_u32 m0, s24, 40960
    s_add_u32 s28, s26, 40960
    buffer_load_dwordx4 v3, s[12:15], s28 offen lds
    s_add_u32 m0, s24, 106496
    s_add_u32 s28, s27, 40960
    buffer_load_dwordx4 v3, s[12:15], s28 offen lds
    s_add_u32 m0, s24, 49152
    s_add_u32 s28, s26, 49152
    buffer_load_dwordx4 v3, s[12:15], s28 offen lds
    s_add_u32 m0, s24, 114688
    s_add_u32 s28, s27, 49152
    buffer_load_dwordx4 v3, s[12:15], s28 offen lds
    s_add_u32 m0, s24, 57344
    s_add_u32 s28, s26, 57344
    buffer_load_dwordx4 v3, s[12:15], s28 offen lds
    s_add_u32 m0, s24, 122880
    s_add_u32 s28, s27, 57344
    buffer_load_dwordx4 v3, s[12:15], s28 offen lds
    v_and_b32 v8, 31, v1
    v_lshrrev_b32 v9, 5, v1
    v_cmp_eq_u32 vcc, 16, v8
    s_mov_b64 s[30:31], vcc
    v_cmp_eq_u32 vcc, 20, v8
    s_or_b64 vcc, vcc, s[30:31]
    v_mov_b32 v10, 0x3f803f80
    s_nop 1
    v_cndmask_b32 v10, 0, v10, vcc
    v_mov_b32 v100, v10
    v_mov_b32 v101, v10
    v_mov_b32 v102, v10
    v_mov_b32 v103, v10
    v_mov_b32 v104, v10
    v_mov_b32 v105, v10
    v_mov_b32 v106, v10
    v_mov_b32 v107, v10
    v_mov_b32 v108, v10
    v_mov_b32 v109, v10
    v_mov_b32 v110, v10
    v_mov_b32 v111, v10
    v_mov_b32 v112, v10
    v_mov_b32 v113, v10
    v_mov_b32 v114, v10
    v_mov_b32 v115, v10
    v_mov_b32 v64, 0
    v_mov_b32 v65, 0
    v_mov_b32 v66, 0
    v_mov_b32 v67, 0
    v_mov_b32 v68, 0
    v_mov_b32 v69, 0
    v_mov_b32 v70, 0
    v_mov_b32 v71, 0
    v_mov_b32 v72, 0
    v_mov_b32 v73, 0
    v_mov_b32 v74, 0
    v_mov_b32 v75, 0
    v_mov_b32 v76, 0
    v_mov_b32 v77, 0
    v_mov_b32 v78, 0
    v_mov_b32 v79, 0
    v_mov_b32 v119, 0x5d800000
    v_mov_b32 v116, v3
    v_and_b32 v11, 15, v8
    v_lshlrev_b32 v117, 4, v11
    v_lshl_add_u32 v117, v9, 8, v117
    v_add_u32 v117, 0x10000, v117
    s_mov_b32 s34, 0x0000ffff
    s_mov_b32 s35, 0x0000ffff
    s_setprio 2
    s_waitcnt vmcnt(12)
    s_barrier
    ds_read_b128 v[92:95], v116
    ds_read_b128 v[96:99], v116 offset:1024
    s_mov_b64 exec, s[34:35]
    ds_read_b128 v[100:103], v117
    ds_read_b128 v[104:107], v117 offset:512
    s_mov_b64 exec, -1
    s_waitcnt lgkmcnt(3)
    v_mfma_f32_32x32x16_bf16 v[48:63], v[92:95], v[4:7], 0
    s_nop 15
    s_nop 3
    v_max3_f32 v8, v48, v49, v50
    v_max3_f32 v8, v8, v51, v52
    v_max3_f32 v8, v8, v53, v54
    v_max3_f32 v8, v8, v55, v56
    v_max3_f32 v8, v8, v57, v58
    v_max3_f32 v8, v8, v59, v60
    v_max3_f32 v8, v8, v61, v62
    v_max_f32 v8, v8, v63
    v_mov_b32 v9, v8
    s_nop 1
    v_permlane32_swap_b32 v8, v9
    v_max_f32 v8, v8, v9
    v_sub_f32 v8, 0, v8
    v_mov_b32 v16, v8
    v_mov_b32 v17, v8
    v_mov_b32 v18, v8
    v_mov_b32 v19, v8
    v_mov_b32 v20, v8
    v_mov_b32 v21, v8
    v_mov_b32 v22, v8
    v_mov_b32 v23, v8
    v_mov_b32 v24, v8
    v_mov_b32 v25, v8
    v_mov_b32 v26, v8
    v_mov_b32 v27, v8
    v_mov_b32 v28, v8
    v_mov_b32 v29, v8
    v_mov_b32 v30, v8
    v_mov_b32 v31, v8
    s_nop 1
    v_mfma_f32_32x32x16_bf16 v[32:47], v[92:95], v[4:7], v[16:31]
    s_mov_b32 s36, 16
k2_kernel_aloop:
    s_waitcnt lgkmcnt(2)
    v_mfma_f32_32x32x16_bf16 v[48:63], v[96:99], v[4:7], v[16:31]
    ds_read_b128 v[92:95], v116 offset:2048
    s_mov_b64 exec, s[34:35]
    ds_read_b128 v[108:111], v117 offset:1024
    ds_read_b128 v[112:115], v117 offset:1536
    s_mov_b64 exec, -1
    v_exp_f32 v84, v32
    v_exp_f32 v85, v33
    v_exp_f32 v86, v34
    v_exp_f32 v87, v35
    v_exp_f32 v88, v36
    v_cvt_pk_bf16_f32 v80, v84, v85
    v_exp_f32 v89, v37
    v_cvt_pk_bf16_f32 v81, v86, v87
    v_exp_f32 v90, v38
    v_exp_f32 v91, v39
    v_cvt_pk_bf16_f32 v82, v88, v89
    v_cvt_pk_bf16_f32 v83, v90, v91
    v_exp_f32 v84, v40
    v_exp_f32 v85, v41
    s_waitcnt lgkmcnt(3)
    v_mfma_f32_32x32x16_bf16 v[64:79], v[100:103], v[80:83], v[64:79]
    v_exp_f32 v86, v42
    v_exp_f32 v87, v43
    v_exp_f32 v88, v44
    v_cvt_pk_bf16_f32 v84, v84, v85
    v_exp_f32 v89, v45
    v_cvt_pk_bf16_f32 v85, v86, v87
    v_exp_f32 v90, v46
    v_exp_f32 v91, v47
    v_cvt_pk_bf16_f32 v86, v88, v89
    v_cvt_pk_bf16_f32 v87, v90, v91
    s_nop 1
    v_mfma_f32_32x32x16_bf16 v[64:79], v[104:107], v[84:87], v[64:79]
    s_waitcnt lgkmcnt(2)
    v_mfma_f32_32x32x16_bf16 v[32:47], v[92:95], v[4:7], v[16:31]
    ds_read_b128 v[96:99], v116 offset:3072
    s_mov_b64 exec, s[34:35]
    ds_read_b128 v[100:103], v117 offset:2048
    ds_read_b128 v[104:107], v117 offset:2560
    s_mov_b64 exec, -1
    v_exp_f32 v84, v48
    v_exp_f32 v85, v49
    v_exp_f32 v86, v50
    v_exp_f32 v87, v51
    v_exp_f32 v88, v52
    v_cvt_pk_bf16_f32 v80, v84, v85
    v_exp_f32 v89, v53
    v_cvt_pk_bf16_f32 v81, v86, v87
    v_exp_f32 v90, v54
    v_exp_f32 v91, v55
    v_cvt_pk_bf16_f32 v82, v88, v89
    v_cvt_pk_bf16_f32 v83, v90, v91
    v_exp_f32 v84, v56
    v_exp_f32 v85, v57
    s_waitcnt lgkmcnt(3)
    v_mfma_f32_32x32x16_bf16 v[64:79], v[108:111], v[80:83], v[64:79]
    v_exp_f32 v86, v58
    v_exp_f32 v87, v59
    v_exp_f32 v88, v60
    v_cvt_pk_bf16_f32 v84, v84, v85
    v_exp_f32 v89, v61
    v_cvt_pk_bf16_f32 v85, v86, v87
    v_exp_f32 v90, v62
    v_exp_f32 v91, v63
    v_cvt_pk_bf16_f32 v86, v88, v89
    v_cvt_pk_bf16_f32 v87, v90, v91
    s_nop 1
    v_mfma_f32_32x32x16_bf16 v[64:79], v[112:115], v[84:87], v[64:79]
    s_waitcnt lgkmcnt(2)
    v_mfma_f32_32x32x16_bf16 v[48:63], v[96:99], v[4:7], v[16:31]
    ds_read_b128 v[92:95], v116 offset:4096
    s_mov_b64 exec, s[34:35]
    ds_read_b128 v[108:111], v117 offset:3072
    ds_read_b128 v[112:115], v117 offset:3584
    s_mov_b64 exec, -1
    v_exp_f32 v84, v32
    v_exp_f32 v85, v33
    v_exp_f32 v86, v34
    v_exp_f32 v87, v35
    v_exp_f32 v88, v36
    v_cvt_pk_bf16_f32 v80, v84, v85
    v_exp_f32 v89, v37
    v_cvt_pk_bf16_f32 v81, v86, v87
    v_exp_f32 v90, v38
    v_exp_f32 v91, v39
    v_cvt_pk_bf16_f32 v82, v88, v89
    v_cvt_pk_bf16_f32 v83, v90, v91
    v_exp_f32 v84, v40
    v_exp_f32 v85, v41
    s_waitcnt lgkmcnt(3)
    v_mfma_f32_32x32x16_bf16 v[64:79], v[100:103], v[80:83], v[64:79]
    v_exp_f32 v86, v42
    v_exp_f32 v87, v43
    v_exp_f32 v88, v44
    v_cvt_pk_bf16_f32 v84, v84, v85
    v_exp_f32 v89, v45
    v_cvt_pk_bf16_f32 v85, v86, v87
    v_exp_f32 v90, v46
    v_exp_f32 v91, v47
    v_cvt_pk_bf16_f32 v86, v88, v89
    v_cvt_pk_bf16_f32 v87, v90, v91
    s_nop 1
    v_mfma_f32_32x32x16_bf16 v[64:79], v[104:107], v[84:87], v[64:79]
    s_waitcnt lgkmcnt(2)
    v_mfma_f32_32x32x16_bf16 v[32:47], v[92:95], v[4:7], v[16:31]
    ds_read_b128 v[96:99], v116 offset:5120
    s_mov_b64 exec, s[34:35]
    ds_read_b128 v[100:103], v117 offset:4096
    ds_read_b128 v[104:107], v117 offset:4608
    s_mov_b64 exec, -1
    v_exp_f32 v84, v48
    v_exp_f32 v85, v49
    v_exp_f32 v86, v50
    v_exp_f32 v87, v51
    v_exp_f32 v88, v52
    v_cvt_pk_bf16_f32 v80, v84, v85
    v_exp_f32 v89, v53
    v_cvt_pk_bf16_f32 v81, v86, v87
    v_exp_f32 v90, v54
    v_exp_f32 v91, v55
    v_cvt_pk_bf16_f32 v82, v88, v89
    v_cvt_pk_bf16_f32 v83, v90, v91
    v_exp_f32 v84, v56
    v_exp_f32 v85, v57
    s_waitcnt lgkmcnt(3)
    v_mfma_f32_32x32x16_bf16 v[64:79], v[108:111], v[80:83], v[64:79]
    v_exp_f32 v86, v58
    v_exp_f32 v87, v59
    v_exp_f32 v88, v60
    v_cvt_pk_bf16_f32 v84, v84, v85
    v_exp_f32 v89, v61
    v_cvt_pk_bf16_f32 v85, v86, v87
    v_exp_f32 v90, v62
    v_exp_f32 v91, v63
    v_cvt_pk_bf16_f32 v86, v88, v89
    v_cvt_pk_bf16_f32 v87, v90, v91
    s_nop 1
    v_mfma_f32_32x32x16_bf16 v[64:79], v[112:115], v[84:87], v[64:79]
    v_add_u32 v116, 0x1000, v116
    v_add_u32 v117, 0x1000, v117
    s_sub_u32 s36, s36, 1
    s_cmp_lg_u32 s36, 14
    s_cbranch_scc1 k2_kernel_anb
    s_waitcnt vmcnt(0)
    s_barrier
k2_kernel_anb:
    s_cmp_lg_u32 s36, 0
    s_cbranch_scc1 k2_kernel_aloop
    s_nop 15
    s_nop 3
    v_cmp_nlt_f32 vcc, v72, v119
    s_cbranch_vccnz k2_kernel_safe
k2_kernel_norm:
    v_rcp_f32 v8, v72
    s_nop 0
    v_mul_f32 v64, v64, v8
    v_mul_f32 v65, v65, v8
    v_mul_f32 v66, v66, v8
    v_mul_f32 v67, v67, v8
    v_mul_f32 v68, v68, v8
    v_mul_f32 v69, v69, v8
    v_mul_f32 v70, v70, v8
    v_mul_f32 v71, v71, v8
    v_cvt_pk_bf16_f32 v80, v64, v65
    v_cvt_pk_bf16_f32 v81, v66, v67
    v_cvt_pk_bf16_f32 v82, v68, v69
    v_cvt_pk_bf16_f32 v83, v70, v71
    s_lshl_b32 s30, s29, 5
    s_add_u32 s30, s30, s21
    s_lshl_b32 s30, s30, 10
    s_add_u32 s30, s30, 0x600000
    buffer_store_dwordx4 v[80:83], v3, s[12:15], s30 offen
    s_endpgm
k2_kernel_safe:
    v_mov_b32 v116, v3
    v_and_b32 v8, 31, v1
    v_lshrrev_b32 v9, 5, v1
    v_and_b32 v11, 15, v8
    v_lshlrev_b32 v117, 4, v11
    v_lshl_add_u32 v117, v9, 8, v117
    v_add_u32 v117, 0x10000, v117
    v_mov_b32 v10, 0xff7fffff
    v_mov_b32 v64, 0
    v_mov_b32 v65, 0
    v_mov_b32 v66, 0
    v_mov_b32 v67, 0
    v_mov_b32 v68, 0
    v_mov_b32 v69, 0
    v_mov_b32 v70, 0
    v_mov_b32 v71, 0
    v_mov_b32 v72, 0
    v_mov_b32 v73, 0
    v_mov_b32 v74, 0
    v_mov_b32 v75, 0
    v_mov_b32 v76, 0
    v_mov_b32 v77, 0
    v_mov_b32 v78, 0
    v_mov_b32 v79, 0
    s_mov_b32 s36, 64
k2_kernel_sloop:
    ds_read_b128 v[92:95], v116
    s_mov_b64 exec, s[34:35]
    ds_read_b128 v[100:103], v117
    ds_read_b128 v[104:107], v117 offset:512
    s_mov_b64 exec, -1
    s_waitcnt lgkmcnt(0)
    v_mfma_f32_32x32x16_bf16 v[32:47], v[92:95], v[4:7], 0
    s_nop 15
    s_nop 3
    v_max3_f32 v8, v32, v33, v34
    v_max3_f32 v8, v8, v35, v36
    v_max3_f32 v8, v8, v37, v38
    v_max3_f32 v8, v8, v39, v40
    v_max3_f32 v8, v8, v41, v42
    v_max3_f32 v8, v8, v43, v44
    v_max3_f32 v8, v8, v45, v46
    v_max_f32 v8, v8, v47
    v_mov_b32 v9, v8
    s_nop 1
    v_permlane32_swap_b32 v8, v9
    v_max3_f32 v8, v8, v9, v10
    v_sub_f32 v9, v10, v8
    v_exp_f32 v9, v9
    v_mov_b32 v10, v8
    v_mul_f32 v64, v64, v9
    v_mul_f32 v65, v65, v9
    v_mul_f32 v66, v66, v9
    v_mul_f32 v67, v67, v9
    v_mul_f32 v68, v68, v9
    v_mul_f32 v69, v69, v9
    v_mul_f32 v70, v70, v9
    v_mul_f32 v71, v71, v9
    v_mul_f32 v72, v72, v9
    v_mul_f32 v73, v73, v9
    v_mul_f32 v74, v74, v9
    v_mul_f32 v75, v75, v9
    v_mul_f32 v76, v76, v9
    v_mul_f32 v77, v77, v9
    v_mul_f32 v78, v78, v9
    v_mul_f32 v79, v79, v9
    v_sub_f32 v32, v32, v8
    v_exp_f32 v32, v32
    v_sub_f32 v33, v33, v8
    v_exp_f32 v33, v33
    v_sub_f32 v34, v34, v8
    v_exp_f32 v34, v34
    v_sub_f32 v35, v35, v8
    v_exp_f32 v35, v35
    v_sub_f32 v36, v36, v8
    v_exp_f32 v36, v36
    v_sub_f32 v37, v37, v8
    v_exp_f32 v37, v37
    v_sub_f32 v38, v38, v8
    v_exp_f32 v38, v38
    v_sub_f32 v39, v39, v8
    v_exp_f32 v39, v39
    v_sub_f32 v40, v40, v8
    v_exp_f32 v40, v40
    v_sub_f32 v41, v41, v8
    v_exp_f32 v41, v41
    v_sub_f32 v42, v42, v8
    v_exp_f32 v42, v42
    v_sub_f32 v43, v43, v8
    v_exp_f32 v43, v43
    v_sub_f32 v44, v44, v8
    v_exp_f32 v44, v44
    v_sub_f32 v45, v45, v8
    v_exp_f32 v45, v45
    v_sub_f32 v46, v46, v8
    v_exp_f32 v46, v46
    v_sub_f32 v47, v47, v8
    v_exp_f32 v47, v47
    s_nop 0
    v_cvt_pk_bf16_f32 v80, v32, v33
    v_cvt_pk_bf16_f32 v81, v34, v35
    v_cvt_pk_bf16_f32 v82, v36, v37
    v_cvt_pk_bf16_f32 v83, v38, v39
    v_cvt_pk_bf16_f32 v84, v40, v41
    v_cvt_pk_bf16_f32 v85, v42, v43
    v_cvt_pk_bf16_f32 v86, v44, v45
    v_cvt_pk_bf16_f32 v87, v46, v47
    s_nop 1
    v_mfma_f32_32x32x16_bf16 v[64:79], v[100:103], v[80:83], v[64:79]
    v_mfma_f32_32x32x16_bf16 v[64:79], v[104:107], v[84:87], v[64:79]
    v_add_u32 v116, 0x400, v116
    v_add_u32 v117, 0x400, v117
    s_sub_u32 s36, s36, 1
    s_cmp_lg_u32 s36, 0
    s_cbranch_scc1 k2_kernel_sloop
    s_nop 15
    s_nop 3
    s_branch k2_kernel_norm
k2_kernel_ffn:
    s_sub_u32 s23, s20, 8
    s_lshr_b32 s24, s23, 1
    s_and_b32 s25, s23, 1
    s_and_b32 s26, s2, 7
    s_bfe_u32 s27, s2, 0x20003
    s_lshl_b32 s27, s27, 3
    s_add_u32 s26, s26, s27
    s_lshr_b32 s27, s2, 5
    s_lshl_b32 s26, s26, 1
    s_add_u32 s26, s26, s24
    s_lshl_b32 s27, s27, 1
    s_add_u32 s27, s27, s25
    s_mul_i32 s28, s26, 114688
    s_add_u32 s28, s28, 0x1000000
    s_mul_i32 s29, s27, 114688
    s_add_u32 s29, s29, 0xa00000
    v_mov_b32 v64, 0
    v_mov_b32 v65, 0
    v_mov_b32 v66, 0
    v_mov_b32 v67, 0
    v_mov_b32 v68, 0
    v_mov_b32 v69, 0
    v_mov_b32 v70, 0
    v_mov_b32 v71, 0
    v_mov_b32 v72, 0
    v_mov_b32 v73, 0
    v_mov_b32 v74, 0
    v_mov_b32 v75, 0
    v_mov_b32 v76, 0
    v_mov_b32 v77, 0
    v_mov_b32 v78, 0
    v_mov_b32 v79, 0
    buffer_load_dwordx4 v[80:83], v3, s[12:15], s28 offen offset:0
    s_add_u32 s30, s29, 0
    buffer_load_dwordx4 v[112:115], v3, s[12:15], s30 offen
    buffer_load_dwordx4 v[84:87], v3, s[12:15], s28 offen offset:1024
    s_add_u32 s30, s29, 1024
    buffer_load_dwordx4 v[116:119], v3, s[12:15], s30 offen
    buffer_load_dwordx4 v[88:91], v3, s[12:15], s28 offen offset:2048
    s_add_u32 s30, s29, 2048
    buffer_load_dwordx4 v[120:123], v3, s[12:15], s30 offen
    buffer_load_dwordx4 v[92:95], v3, s[12:15], s28 offen offset:3072
    s_add_u32 s30, s29, 3072
    buffer_load_dwordx4 v[124:127], v3, s[12:15], s30 offen
    s_add_u32 s30, s28, 4096
    buffer_load_dwordx4 v[96:99], v3, s[12:15], s30 offen
    s_add_u32 s30, s29, 4096
    buffer_load_dwordx4 v[128:131], v3, s[12:15], s30 offen
    s_add_u32 s30, s28, 5120
    buffer_load_dwordx4 v[100:103], v3, s[12:15], s30 offen
    s_add_u32 s30, s29, 5120
    buffer_load_dwordx4 v[132:135], v3, s[12:15], s30 offen
    s_add_u32 s30, s28, 6144
    buffer_load_dwordx4 v[104:107], v3, s[12:15], s30 offen
    s_add_u32 s30, s29, 6144
    buffer_load_dwordx4 v[136:139], v3, s[12:15], s30 offen
    s_add_u32 s30, s28, 7168
    buffer_load_dwordx4 v[108:111], v3, s[12:15], s30 offen
    s_add_u32 s30, s29, 7168
    buffer_load_dwordx4 v[140:143], v3, s[12:15], s30 offen
    s_barrier
    s_barrier
    s_add_u32 s28, s28, 8192
    s_add_u32 s29, s29, 8192
    s_mov_b32 s36, 13
k2_kernel_floop:
    s_waitcnt vmcnt(14)
    v_mfma_f32_32x32x16_bf16 v[64:79], v[112:115], v[80:83], v[64:79]
    s_add_u32 s30, s28, 0
    buffer_load_dwordx4 v[80:83], v3, s[12:15], s30 offen
    s_add_u32 s30, s29, 0
    buffer_load_dwordx4 v[112:115], v3, s[12:15], s30 offen
    s_waitcnt vmcnt(14)
    v_mfma_f32_32x32x16_bf16 v[64:79], v[116:119], v[84:87], v[64:79]
    s_add_u32 s30, s28, 1024
    buffer_load_dwordx4 v[84:87], v3, s[12:15], s30 offen
    s_add_u32 s30, s29, 1024
    buffer_load_dwordx4 v[116:119], v3, s[12:15], s30 offen
    s_waitcnt vmcnt(14)
    v_mfma_f32_32x32x16_bf16 v[64:79], v[120:123], v[88:91], v[64:79]
    s_add_u32 s30, s28, 2048
    buffer_load_dwordx4 v[88:91], v3, s[12:15], s30 offen
    s_add_u32 s30, s29, 2048
    buffer_load_dwordx4 v[120:123], v3, s[12:15], s30 offen
    s_waitcnt vmcnt(14)
    v_mfma_f32_32x32x16_bf16 v[64:79], v[124:127], v[92:95], v[64:79]
    s_add_u32 s30, s28, 3072
    buffer_load_dwordx4 v[92:95], v3, s[12:15], s30 offen
    s_add_u32 s30, s29, 3072
    buffer_load_dwordx4 v[124:127], v3, s[12:15], s30 offen
    s_waitcnt vmcnt(14)
    v_mfma_f32_32x32x16_bf16 v[64:79], v[128:131], v[96:99], v[64:79]
    s_add_u32 s30, s28, 4096
    buffer_load_dwordx4 v[96:99], v3, s[12:15], s30 offen
    s_add_u32 s30, s29, 4096
    buffer_load_dwordx4 v[128:131], v3, s[12:15], s30 offen
    s_waitcnt vmcnt(14)
    v_mfma_f32_32x32x16_bf16 v[64:79], v[132:135], v[100:103], v[64:79]
    s_add_u32 s30, s28, 5120
    buffer_load_dwordx4 v[100:103], v3, s[12:15], s30 offen
    s_add_u32 s30, s29, 5120
    buffer_load_dwordx4 v[132:135], v3, s[12:15], s30 offen
    s_waitcnt vmcnt(14)
    v_mfma_f32_32x32x16_bf16 v[64:79], v[136:139], v[104:107], v[64:79]
    s_add_u32 s30, s28, 6144
    buffer_load_dwordx4 v[104:107], v3, s[12:15], s30 offen
    s_add_u32 s30, s29, 6144
    buffer_load_dwordx4 v[136:139], v3, s[12:15], s30 offen
    s_waitcnt vmcnt(14)
    v_mfma_f32_32x32x16_bf16 v[64:79], v[140:143], v[108:111], v[64:79]
    s_add_u32 s30, s28, 7168
    buffer_load_dwordx4 v[108:111], v3, s[12:15], s30 offen
    s_add_u32 s30, s29, 7168
    buffer_load_dwordx4 v[140:143], v3, s[12:15], s30 offen
    s_add_u32 s28, s28, 8192
    s_add_u32 s29, s29, 8192
    s_sub_u32 s36, s36, 1
    s_cmp_lg_u32 s36, 0
    s_cbranch_scc1 k2_kernel_floop
    s_waitcnt vmcnt(14)
    v_mfma_f32_32x32x16_bf16 v[64:79], v[112:115], v[80:83], v[64:79]
    s_waitcnt vmcnt(12)
    v_mfma_f32_32x32x16_bf16 v[64:79], v[116:119], v[84:87], v[64:79]
    s_waitcnt vmcnt(10)
    v_mfma_f32_32x32x16_bf16 v[64:79], v[120:123], v[88:91], v[64:79]
    s_waitcnt vmcnt(8)
    v_mfma_f32_32x32x16_bf16 v[64:79], v[124:127], v[92:95], v[64:79]
    s_waitcnt vmcnt(6)
    v_mfma_f32_32x32x16_bf16 v[64:79], v[128:131], v[96:99], v[64:79]
    s_waitcnt vmcnt(4)
    v_mfma_f32_32x32x16_bf16 v[64:79], v[132:135], v[100:103], v[64:79]
    s_waitcnt vmcnt(2)
    v_mfma_f32_32x32x16_bf16 v[64:79], v[136:139], v[104:107], v[64:79]
    s_waitcnt vmcnt(0)
    v_mfma_f32_32x32x16_bf16 v[64:79], v[140:143], v[108:111], v[64:79]
    v_lshrrev_b32 v9, 5, v1
    v_and_b32 v8, 31, v1
    v_lshlrev_b32 v10, 3, v9
    s_lshl_b32 s30, s27, 6
    v_add_u32 v10, s30, v10
    buffer_load_dwordx2 v[96:97], v10, s[16:19], 0 offen offset:0
    buffer_load_dwordx2 v[98:99], v10, s[16:19], 0 offen offset:16
    buffer_load_dwordx2 v[100:101], v10, s[16:19], 0 offen offset:32
    buffer_load_dwordx2 v[102:103], v10, s[16:19], 0 offen offset:48
    s_lshl_b32 s31, s26, 5
    v_add_u32 v11, s31, v8
    v_lshlrev_b32 v11, 10, v11
    v_lshl_add_u32 v11, v9, 4, v11
    s_lshl_b32 s30, s27, 6
    v_add_u32 v11, s30, v11
    s_nop 7
    s_nop 7
    v_cvt_pk_bf16_f32 v80, v64, v65
    v_cvt_pk_bf16_f32 v81, v66, v67
    v_cvt_pk_bf16_f32 v82, v68, v69
    v_cvt_pk_bf16_f32 v83, v70, v71
    v_cvt_pk_bf16_f32 v84, v72, v73
    v_cvt_pk_bf16_f32 v85, v74, v75
    v_cvt_pk_bf16_f32 v86, v76, v77
    v_cvt_pk_bf16_f32 v87, v78, v79
    s_waitcnt vmcnt(0)
    v_lshlrev_b32 v64, 16, v80
    v_and_b32 v65, 0xffff0000, v80
    v_lshlrev_b32 v88, 16, v96
    v_and_b32 v89, 0xffff0000, v96
    v_add_f32 v64, v64, v88
    v_add_f32 v65, v65, v89
    v_lshlrev_b32 v66, 16, v81
    v_and_b32 v67, 0xffff0000, v81
    v_lshlrev_b32 v88, 16, v97
    v_and_b32 v89, 0xffff0000, v97
    v_add_f32 v66, v66, v88
    v_add_f32 v67, v67, v89
    v_lshlrev_b32 v68, 16, v82
    v_and_b32 v69, 0xffff0000, v82
    v_lshlrev_b32 v88, 16, v98
    v_and_b32 v89, 0xffff0000, v98
    v_add_f32 v68, v68, v88
    v_add_f32 v69, v69, v89
    v_lshlrev_b32 v70, 16, v83
    v_and_b32 v71, 0xffff0000, v83
    v_lshlrev_b32 v88, 16, v99
    v_and_b32 v89, 0xffff0000, v99
    v_add_f32 v70, v70, v88
    v_add_f32 v71, v71, v89
    v_lshlrev_b32 v72, 16, v84
    v_and_b32 v73, 0xffff0000, v84
    v_lshlrev_b32 v88, 16, v100
    v_and_b32 v89, 0xffff0000, v100
    v_add_f32 v72, v72, v88
    v_add_f32 v73, v73, v89
    v_lshlrev_b32 v74, 16, v85
    v_and_b32 v75, 0xffff0000, v85
    v_lshlrev_b32 v88, 16, v101
    v_and_b32 v89, 0xffff0000, v101
    v_add_f32 v74, v74, v88
    v_add_f32 v75, v75, v89
    v_lshlrev_b32 v76, 16, v86
    v_and_b32 v77, 0xffff0000, v86
    v_lshlrev_b32 v88, 16, v102
    v_and_b32 v89, 0xffff0000, v102
    v_add_f32 v76, v76, v88
    v_add_f32 v77, v77, v89
    v_lshlrev_b32 v78, 16, v87
    v_and_b32 v79, 0xffff0000, v87
    v_lshlrev_b32 v88, 16, v103
    v_and_b32 v89, 0xffff0000, v103
    v_add_f32 v78, v78, v88
    v_add_f32 v79, v79, v89
    v_cvt_pk_bf16_f32 v80, v64, v65
    v_cvt_pk_bf16_f32 v81, v66, v67
    v_cvt_pk_bf16_f32 v82, v68, v69
    v_cvt_pk_bf16_f32 v83, v70, v71
    v_cvt_pk_bf16_f32 v84, v72, v73
    v_cvt_pk_bf16_f32 v85, v74, v75
    v_cvt_pk_bf16_f32 v86, v76, v77
    v_cvt_pk_bf16_f32 v87, v78, v79
    s_nop 1
    v_permlane32_swap_b32 v80, v82
    v_permlane32_swap_b32 v81, v83
    v_permlane32_swap_b32 v84, v86
    v_permlane32_swap_b32 v85, v87
    s_nop 1
    s_mov_b32 s30, 0x800000
    buffer_store_dwordx4 v[80:83], v11, s[12:15], s30 offen
    buffer_store_dwordx4 v[84:87], v11, s[12:15], s30 offen offset:32
k2_kernel_exit:
    s_endpgm
.globl k3_kernel
.p2align 8
.type k3_kernel,@function
k3_kernel:
    s_cmp_ge_u32 s2, 256
    s_cbranch_scc1 k3_kernel_exit
    s_load_dwordx2 s[66:67], s[0:1], 80
    s_load_dwordx2 s[68:69], s[0:1], 0
    s_load_dwordx2 s[70:71], s[0:1], 64
    v_and_b32 v1, 63, v0
    v_lshrrev_b32 v2, 6, v0
    s_nop 0
    v_readfirstlane_b32 s20, v2
    v_lshlrev_b32 v3, 4, v1
    s_waitcnt lgkmcnt(0)
    s_mov_b32 s12, s66
    s_and_b32 s13, s67, 0xffff
    s_mov_b32 s14, 0x10000000
    s_mov_b32 s15, 0x00020000
    s_mov_b32 s16, s68
    s_and_b32 s17, s69, 0xffff
    s_mov_b32 s18, 0x200000
    s_mov_b32 s19, 0x00020000
    s_mov_b32 s4, s70
    s_and_b32 s5, s71, 0xffff
    s_mov_b32 s6, 0x200000
    s_mov_b32 s7, 0x00020000
    s_and_b32 s23, s20, 3
    s_lshr_b32 s22, s20, 2
    s_lshr_b32 s24, s23, 1
    s_and_b32 s25, s23, 1
    s_and_b32 s26, s2, 7
    s_bfe_u32 s27, s2, 0x20003
    s_lshl_b32 s27, s27, 3
    s_add_u32 s26, s26, s27
    s_lshr_b32 s27, s2, 5
    s_lshl_b32 s26, s26, 1
    s_add_u32 s26, s26, s24
    s_lshl_b32 s27, s27, 1
    s_add_u32 s27, s27, s25
    s_lshl_b32 s28, s26, 15
    s_add_u32 s28, s28, 0x600000
    s_lshl_b32 s29, s27, 15
    s_add_u32 s29, s29, 0xc00000
    s_lshl_b32 s31, s22, 14
    s_add_u32 s28, s28, s31
    s_add_u32 s29, s29, s31
    v_mov_b32 v16, 0
    v_mov_b32 v17, 0
    v_mov_b32 v18, 0
    v_mov_b32 v19, 0
    v_mov_b32 v20, 0
    v_mov_b32 v21, 0
    v_mov_b32 v22, 0
    v_mov_b32 v23, 0
    v_mov_b32 v24, 0
    v_mov_b32 v25, 0
    v_mov_b32 v26, 0
    v_mov_b32 v27, 0
    v_mov_b32 v28, 0
    v_mov_b32 v29, 0
    v_mov_b32 v30, 0
    v_mov_b32 v31, 0
    s_add_u32 s30, s28, 0
    buffer_load_dwordx4 v[32:35], v3, s[12:15], s30 offen
    s_add_u32 s30, s29, 0
    buffer_load_dwordx4 v[96:99], v3, s[12:15], s30 offen
    s_add_u32 s30, s28, 1024
    buffer_load_dwordx4 v[36:39], v3, s[12:15], s30 offen
    s_add_u32 s30, s29, 1024
    buffer_load_dwordx4 v[100:103], v3, s[12:15], s30 offen
    s_add_u32 s30, s28, 2048
    buffer_load_dwordx4 v[40:43], v3, s[12:15], s30 offen
    s_add_u32 s30, s29, 2048
    buffer_load_dwordx4 v[104:107], v3, s[12:15], s30 offen
    s_add_u32 s30, s28, 3072
    buffer_load_dwordx4 v[44:47], v3, s[12:15], s30 offen
    s_add_u32 s30, s29, 3072
    buffer_load_dwordx4 v[108:111], v3, s[12:15], s30 offen
    s_add_u32 s30, s28, 4096
    buffer_load_dwordx4 v[48:51], v3, s[12:15], s30 offen
    s_add_u32 s30, s29, 4096
    buffer_load_dwordx4 v[112:115], v3, s[12:15], s30 offen
    s_add_u32 s30, s28, 5120
    buffer_load_dwordx4 v[52:55], v3, s[12:15], s30 offen
    s_add_u32 s30, s29, 5120
    buffer_load_dwordx4 v[116:119], v3, s[12:15], s30 offen
    s_add_u32 s30, s28, 6144
    buffer_load_dwordx4 v[56:59], v3, s[12:15], s30 offen
    s_add_u32 s30, s29, 6144
    buffer_load_dwordx4 v[120:123], v3, s[12:15], s30 offen
    s_add_u32 s30, s28, 7168
    buffer_load_dwordx4 v[60:63], v3, s[12:15], s30 offen
    s_add_u32 s30, s29, 7168
    buffer_load_dwordx4 v[124:127], v3, s[12:15], s30 offen
    s_add_u32 s30, s28, 8192
    buffer_load_dwordx4 v[64:67], v3, s[12:15], s30 offen
    s_add_u32 s30, s29, 8192
    buffer_load_dwordx4 v[128:131], v3, s[12:15], s30 offen
    s_add_u32 s30, s28, 9216
    buffer_load_dwordx4 v[68:71], v3, s[12:15], s30 offen
    s_add_u32 s30, s29, 9216
    buffer_load_dwordx4 v[132:135], v3, s[12:15], s30 offen
    s_add_u32 s30, s28, 10240
    buffer_load_dwordx4 v[72:75], v3, s[12:15], s30 offen
    s_add_u32 s30, s29, 10240
    buffer_load_dwordx4 v[136:139], v3, s[12:15], s30 offen
    s_add_u32 s30, s28, 11264
    buffer_load_dwordx4 v[76:79], v3, s[12:15], s30 offen
    s_add_u32 s30, s29, 11264
    buffer_load_dwordx4 v[140:143], v3, s[12:15], s30 offen
    s_add_u32 s30, s28, 12288
    buffer_load_dwordx4 v[80:83], v3, s[12:15], s30 offen
    s_add_u32 s30, s29, 12288
    buffer_load_dwordx4 v[144:147], v3, s[12:15], s30 offen
    s_add_u32 s30, s28, 13312
    buffer_load_dwordx4 v[84:87], v3, s[12:15], s30 offen
    s_add_u32 s30, s29, 13312
    buffer_load_dwordx4 v[148:151], v3, s[12:15], s30 offen
    s_add_u32 s30, s28, 14336
    buffer_load_dwordx4 v[88:91], v3, s[12:15], s30 offen
    s_add_u32 s30, s29, 14336
    buffer_load_dwordx4 v[152:155], v3, s[12:15], s30 offen
    s_add_u32 s30, s28, 15360
    buffer_load_dwordx4 v[92:95], v3, s[12:15], s30 offen
    s_add_u32 s30, s29, 15360
    buffer_load_dwordx4 v[156:159], v3, s[12:15], s30 offen
    v_lshrrev_b32 v9, 5, v1
    v_and_b32 v8, 31, v1
    s_lshl_b32 s31, s26, 5
    v_add_u32 v11, s31, v8
    v_lshlrev_b32 v11, 10, v11
    v_lshl_add_u32 v11, v9, 4, v11
    s_lshl_b32 s30, s27, 6
    v_add_u32 v11, s30, v11
    buffer_load_dwordx4 v[160:163], v11, s[16:19], 0 offen
    buffer_load_dwordx4 v[164:167], v11, s[16:19], 0 offen offset:32
    s_mov_b32 s30, 0x800000
    buffer_load_dwordx4 v[168:171], v11, s[12:15], s30 offen
    buffer_load_dwordx4 v[172:175], v11, s[12:15], s30 offen offset:32
    s_waitcnt vmcnt(34)
    v_mfma_f32_32x32x16_bf16 v[16:31], v[96:99], v[32:35], v[16:31]
    s_waitcnt vmcnt(32)
    v_mfma_f32_32x32x16_bf16 v[16:31], v[100:103], v[36:39], v[16:31]
    s_waitcnt vmcnt(30)
    v_mfma_f32_32x32x16_bf16 v[16:31], v[104:107], v[40:43], v[16:31]
    s_waitcnt vmcnt(28)
    v_mfma_f32_32x32x16_bf16 v[16:31], v[108:111], v[44:47], v[16:31]
    s_waitcnt vmcnt(26)
    v_mfma_f32_32x32x16_bf16 v[16:31], v[112:115], v[48:51], v[16:31]
    s_waitcnt vmcnt(24)
    v_mfma_f32_32x32x16_bf16 v[16:31], v[116:119], v[52:55], v[16:31]
    s_waitcnt vmcnt(22)
    v_mfma_f32_32x32x16_bf16 v[16:31], v[120:123], v[56:59], v[16:31]
    s_waitcnt vmcnt(20)
    v_mfma_f32_32x32x16_bf16 v[16:31], v[124:127], v[60:63], v[16:31]
    s_waitcnt vmcnt(18)
    v_mfma_f32_32x32x16_bf16 v[16:31], v[128:131], v[64:67], v[16:31]
    s_waitcnt vmcnt(16)
    v_mfma_f32_32x32x16_bf16 v[16:31], v[132:135], v[68:71], v[16:31]
    s_waitcnt vmcnt(14)
    v_mfma_f32_32x32x16_bf16 v[16:31], v[136:139], v[72:75], v[16:31]
    s_waitcnt vmcnt(12)
    v_mfma_f32_32x32x16_bf16 v[16:31], v[140:143], v[76:79], v[16:31]
    s_waitcnt vmcnt(10)
    v_mfma_f32_32x32x16_bf16 v[16:31], v[144:147], v[80:83], v[16:31]
    s_waitcnt vmcnt(8)
    v_mfma_f32_32x32x16_bf16 v[16:31], v[148:151], v[84:87], v[16:31]
    s_waitcnt vmcnt(6)
    v_mfma_f32_32x32x16_bf16 v[16:31], v[152:155], v[88:91], v[16:31]
    s_waitcnt vmcnt(4)
    v_mfma_f32_32x32x16_bf16 v[16:31], v[156:159], v[92:95], v[16:31]
    s_nop 15
    s_nop 3
    s_lshl_b32 s30, s23, 12
    v_add_u32 v12, s30, v3
    s_cmp_eq_u32 s22, 0
    s_cbranch_scc1 k3_kernel_rd
    ds_write_b128 v12, v[16:19]
    ds_write_b128 v12, v[20:23] offset:1024
    ds_write_b128 v12, v[24:27] offset:2048
    ds_write_b128 v12, v[28:31] offset:3072
    s_waitcnt lgkmcnt(0)
    s_barrier
    s_endpgm
k3_kernel_rd:
    s_barrier
    ds_read_b128 v[96:99], v12
    ds_read_b128 v[100:103], v12 offset:1024
    ds_read_b128 v[104:107], v12 offset:2048
    ds_read_b128 v[108:111], v12 offset:3072
    s_waitcnt lgkmcnt(0)
    v_add_f32 v16, v16, v96
    v_add_f32 v17, v17, v97
    v_add_f32 v18, v18, v98
    v_add_f32 v19, v19, v99
    v_add_f32 v20, v20, v100
    v_add_f32 v21, v21, v101
    v_add_f32 v22, v22, v102
    v_add_f32 v23, v23, v103
    v_add_f32 v24, v24, v104
    v_add_f32 v25, v25, v105
    v_add_f32 v26, v26, v106
    v_add_f32 v27, v27, v107
    v_add_f32 v28, v28, v108
    v_add_f32 v29, v29, v109
    v_add_f32 v30, v30, v110
    v_add_f32 v31, v31, v111
    s_nop 15
    s_nop 3
    v_cvt_pk_bf16_f32 v80, v16, v17
    v_cvt_pk_bf16_f32 v81, v18, v19
    v_cvt_pk_bf16_f32 v82, v20, v21
    v_cvt_pk_bf16_f32 v83, v22, v23
    v_cvt_pk_bf16_f32 v84, v24, v25
    v_cvt_pk_bf16_f32 v85, v26, v27
    v_cvt_pk_bf16_f32 v86, v28, v29
    v_cvt_pk_bf16_f32 v87, v30, v31
    s_nop 1
    v_permlane32_swap_b32 v80, v82
    v_permlane32_swap_b32 v81, v83
    v_permlane32_swap_b32 v84, v86
    v_permlane32_swap_b32 v85, v87
    s_waitcnt vmcnt(0)
    v_lshlrev_b32 v88, 16, v80
    v_and_b32 v89, 0xffff0000, v80
    v_lshlrev_b32 v90, 16, v160
    v_and_b32 v91, 0xffff0000, v160
    v_add_f32 v88, v88, v90
    v_add_f32 v89, v89, v91
    v_cvt_pk_bf16_f32 v92, v88, v89
    v_lshlrev_b32 v88, 16, v92
    v_and_b32 v89, 0xffff0000, v92
    v_lshlrev_b32 v90, 16, v168
    v_and_b32 v91, 0xffff0000, v168
    v_add_f32 v88, v88, v90
    v_add_f32 v89, v89, v91
    v_cvt_pk_bf16_f32 v80, v88, v89
    v_lshlrev_b32 v88, 16, v81
    v_and_b32 v89, 0xffff0000, v81
    v_lshlrev_b32 v90, 16, v161
    v_and_b32 v91, 0xffff0000, v161
    v_add_f32 v88, v88, v90
    v_add_f32 v89, v89, v91
    v_cvt_pk_bf16_f32 v92, v88, v89
    v_lshlrev_b32 v88, 16, v92
    v_and_b32 v89, 0xffff0000, v92
    v_lshlrev_b32 v90, 16, v169
    v_and_b32 v91, 0xffff0000, v169
    v_add_f32 v88, v88, v90
    v_add_f32 v89, v89, v91
    v_cvt_pk_bf16_f32 v81, v88, v89
    v_lshlrev_b32 v88, 16, v82
    v_and_b32 v89, 0xffff0000, v82
    v_lshlrev_b32 v90, 16, v162
    v_and_b32 v91, 0xffff0000, v162
    v_add_f32 v88, v88, v90
    v_add_f32 v89, v89, v91
    v_cvt_pk_bf16_f32 v92, v88, v89
    v_lshlrev_b32 v88, 16, v92
    v_and_b32 v89, 0xffff0000, v92
    v_lshlrev_b32 v90, 16, v170
    v_and_b32 v91, 0xffff0000, v170
    v_add_f32 v88, v88, v90
    v_add_f32 v89, v89, v91
    v_cvt_pk_bf16_f32 v82, v88, v89
    v_lshlrev_b32 v88, 16, v83
    v_and_b32 v89, 0xffff0000, v83
    v_lshlrev_b32 v90, 16, v163
    v_and_b32 v91, 0xffff0000, v163
    v_add_f32 v88, v88, v90
    v_add_f32 v89, v89, v91
    v_cvt_pk_bf16_f32 v92, v88, v89
    v_lshlrev_b32 v88, 16, v92
    v_and_b32 v89, 0xffff0000, v92
    v_lshlrev_b32 v90, 16, v171
    v_and_b32 v91, 0xffff0000, v171
    v_add_f32 v88, v88, v90
    v_add_f32 v89, v89, v91
    v_cvt_pk_bf16_f32 v83, v88, v89
    v_lshlrev_b32 v88, 16, v84
    v_and_b32 v89, 0xffff0000, v84
    v_lshlrev_b32 v90, 16, v164
    v_and_b32 v91, 0xffff0000, v164
    v_add_f32 v88, v88, v90
    v_add_f32 v89, v89, v91
    v_cvt_pk_bf16_f32 v92, v88, v89
    v_lshlrev_b32 v88, 16, v92
    v_and_b32 v89, 0xffff0000, v92
    v_lshlrev_b32 v90, 16, v172
    v_and_b32 v91, 0xffff0000, v172
    v_add_f32 v88, v88, v90
    v_add_f32 v89, v89, v91
    v_cvt_pk_bf16_f32 v84, v88, v89
    v_lshlrev_b32 v88, 16, v85
    v_and_b32 v89, 0xffff0000, v85
    v_lshlrev_b32 v90, 16, v165
    v_and_b32 v91, 0xffff0000, v165
    v_add_f32 v88, v88, v90
    v_add_f32 v89, v89, v91
    v_cvt_pk_bf16_f32 v92, v88, v89
    v_lshlrev_b32 v88, 16, v92
    v_and_b32 v89, 0xffff0000, v92
    v_lshlrev_b32 v90, 16, v173
    v_and_b32 v91, 0xffff0000, v173
    v_add_f32 v88, v88, v90
    v_add_f32 v89, v89, v91
    v_cvt_pk_bf16_f32 v85, v88, v89
    v_lshlrev_b32 v88, 16, v86
    v_and_b32 v89, 0xffff0000, v86
    v_lshlrev_b32 v90, 16, v166
    v_and_b32 v91, 0xffff0000, v166
    v_add_f32 v88, v88, v90
    v_add_f32 v89, v89, v91
    v_cvt_pk_bf16_f32 v92, v88, v89
    v_lshlrev_b32 v88, 16, v92
    v_and_b32 v89, 0xffff0000, v92
    v_lshlrev_b32 v90, 16, v174
    v_and_b32 v91, 0xffff0000, v174
    v_add_f32 v88, v88, v90
    v_add_f32 v89, v89, v91
    v_cvt_pk_bf16_f32 v86, v88, v89
    v_lshlrev_b32 v88, 16, v87
    v_and_b32 v89, 0xffff0000, v87
    v_lshlrev_b32 v90, 16, v167
    v_and_b32 v91, 0xffff0000, v167
    v_add_f32 v88, v88, v90
    v_add_f32 v89, v89, v91
    v_cvt_pk_bf16_f32 v92, v88, v89
    v_lshlrev_b32 v88, 16, v92
    v_and_b32 v89, 0xffff0000, v92
    v_lshlrev_b32 v90, 16, v175
    v_and_b32 v91, 0xffff0000, v175
    v_add_f32 v88, v88, v90
    v_add_f32 v89, v89, v91
    v_cvt_pk_bf16_f32 v87, v88, v89
    s_nop 1
    buffer_store_dwordx4 v[80:83], v11, s[4:7], 0 offen
    buffer_store_dwordx4 v[84:87], v11, s[4:7], 0 offen offset:32
k3_kernel_exit:
    s_endpgm
.section .rodata,"a"
.p2align 6
.amdhsa_kernel k1_kernel
  .amdhsa_next_free_vgpr 208
  .amdhsa_next_free_sgpr 102
  .amdhsa_accum_offset 208
  .amdhsa_group_segment_fixed_size 0
  .amdhsa_kernarg_size 88
  .amdhsa_user_sgpr_count 2
  .amdhsa_user_sgpr_kernarg_segment_ptr 1
  .amdhsa_system_sgpr_workgroup_id_x 1
.end_amdhsa_kernel
.amdhsa_kernel k2_kernel
  .amdhsa_next_free_vgpr 144
  .amdhsa_next_free_sgpr 102
  .amdhsa_accum_offset 144
  .amdhsa_group_segment_fixed_size 0
  .amdhsa_kernarg_size 88
  .amdhsa_user_sgpr_count 2
  .amdhsa_user_sgpr_kernarg_segment_ptr 1
  .amdhsa_system_sgpr_workgroup_id_x 1
.end_amdhsa_kernel
.amdhsa_kernel k3_kernel
  .amdhsa_next_free_vgpr 176
  .amdhsa_next_free_sgpr 102
  .amdhsa_accum_offset 176
  .amdhsa_group_segment_fixed_size 0
  .amdhsa_kernarg_size 88
  .amdhsa_user_sgpr_count 2
  .amdhsa_user_sgpr_kernarg_segment_ptr 1
  .amdhsa_system_sgpr_workgroup_id_x 1
.end_amdhsa_kernel
```
